```python
import torch

def _softmax(x, axis=-1):
    return torch.softmax(x, dim=axis)
def _gelu(x):
    return torch.nn.functional.gelu(x, approximate="tanh")
def _silu(x):
    return torch.nn.functional.silu(x)
def _sigmoid(x):
    return torch.sigmoid(x)
def _layernorm(x, axis=-1, eps=1e-5):
    m = x.mean(dim=axis, keepdim=True)
    v = x.var(dim=axis, keepdim=True, unbiased=False)
    return (x - m) / torch.sqrt(v + eps)
def _scatter_add(tgt, idx, src, axis=0):
    return tgt.clone().index_add_(axis, idx, src)
def _segment_sum(src, seg, n):
    out = torch.zeros((n,) + src.shape[1:], dtype=src.dtype)
    return out.index_add_(0, seg, src)
def _pad(x, pw):
    flat = tuple(v for pair in reversed(pw) for v in pair)
    return torch.nn.functional.pad(x, flat)

kernel_name = 'gated_mix__mha_block_cached__sliding_block_cached__decode'

def setup_inputs():

    _w = (lambda a: (lambda t: t.to(torch.bfloat16) if t.is_floating_point() else t)(torch.as_tensor(a)))
    def _A_setup():
        B, Sq, D = 4, 1, 512
        H, Sk, Dh = 32, 8192, 128
        return {
            "x": _w((lambda *s: torch.randn(*s, dtype=torch.bfloat16) * 0.05)(B, Sq, D)),
            "k_cache": _w((lambda *s: torch.randn(*s, dtype=torch.bfloat16) * 6.4)(B, H, Sk, Dh)),
            "v_cache": _w((lambda *s: torch.randn(*s, dtype=torch.bfloat16) * 0.05)(B, H, Sk, Dh)),
            "wq": _w((lambda *s: torch.randn(*s, dtype=torch.bfloat16) * 6.4)(D, H * Dh) * (D ** -0.5)),
            "wo": _w((lambda *s: torch.randn(*s, dtype=torch.bfloat16) * 0.05)(H * Dh, D) * ((H * Dh) ** -0.5)),
        }
    _A_in = _A_setup()

    def _B_setup():
        B, Sq, D = 4, 1, 512
        Hq, Hkv, Sk, Dh = 32, 8, 8192, 128
        assert Hq % Hkv == 0, (Hq, Hkv)
        return {
            "x": _w((lambda *s: torch.randn(*s, dtype=torch.bfloat16) * 0.05)(B, Sq, D)),
            "k_cache": _w((lambda *s: torch.randn(*s, dtype=torch.bfloat16) * 6.4)(B, Hkv, Sk, Dh)),
            "v_cache": _w((lambda *s: torch.randn(*s, dtype=torch.bfloat16) * 0.05)(B, Hkv, Sk, Dh)),
            "wq": _w((lambda *s: torch.randn(*s, dtype=torch.bfloat16) * 6.4)(D, Hq * Dh) * (D ** -0.5)),
            "wo": _w((lambda *s: torch.randn(*s, dtype=torch.bfloat16) * 0.05)(Hq * Dh, D) * ((Hq * Dh) ** -0.5)),
        }
    _B_in = _B_setup()

    return {
        "A_x": _A_in["x"],
        "A_k_cache": _A_in["k_cache"],
        "A_v_cache": _A_in["v_cache"],
        "A_wq": _A_in["wq"],
        "A_wo": _A_in["wo"],
        "B_x": _B_in["x"],
        "B_k_cache": _B_in["k_cache"],
        "B_v_cache": _B_in["v_cache"],
        "B_wq": _B_in["wq"],
        "B_wo": _B_in["wo"],
        "gate_w": _w((lambda *s: torch.randn(*s, dtype=torch.bfloat16) * 0.05)(512) * 16.0),
    }

def reference(A_x, A_k_cache, A_v_cache, A_wq, A_wo, B_x, B_k_cache, B_v_cache, B_wq, B_wo, gate_w):
    def _A_ref(x, k_cache, v_cache, wq, wo):
        B, Sq, D = x.shape
        H, Dh = 32, 128
        q = (lambda x, *d: x.permute(*d))((x @ wq).reshape(B, Sq, H, Dh), 0, 2, 1, 3)
        scores = torch.einsum("bhqd,bhkd->bhqk", q, k_cache) * (Dh ** -0.5)
        p = _softmax(scores, axis=-1)
        o = torch.einsum("bhqk,bhkd->bhqd", p, v_cache)
        return (lambda x, *d: x.permute(*d))(o, 0, 2, 1, 3).reshape(B, Sq, H * Dh) @ wo

    def _B_ref(x, k_cache, v_cache, wq, wo):
        B, Sq, D = x.shape
        Hq, Dh = 32, 128
        Hkv, Sk = k_cache.shape[1], k_cache.shape[2]
        W = min(4096, max(256, Sk // 4))
        rep = Hq // Hkv
        q = (lambda x, *d: x.permute(*d))((x @ wq).reshape(B, Sq, Hq, Dh), 0, 2, 1, 3)
        k = (lambda x, n, axis: torch.repeat_interleave(x, n, dim=axis))(k_cache[:, :, Sk - W:, :], rep, axis=1)
        v = (lambda x, n, axis: torch.repeat_interleave(x, n, dim=axis))(v_cache[:, :, Sk - W:, :], rep, axis=1)
        scores = torch.einsum("bhqd,bhkd->bhqk", q, k) * (Dh ** -0.5)
        p = _softmax(scores, axis=-1)
        o = torch.einsum("bhqk,bhkd->bhqd", p, v)
        return (lambda x, *d: x.permute(*d))(o, 0, 2, 1, 3).reshape(B, Sq, Hq * Dh) @ wo

    x = A_x
    g = _sigmoid((x * gate_w).sum(-1, keepdims=True))
    a = _A_ref(x, A_k_cache, A_v_cache, A_wq, A_wo)
    b = _B_ref(x, B_k_cache, B_v_cache, B_wq, B_wo)
    return g * a + (1 - g) * b
```

```asm
; @launch grid=(256,1,1) block=(512,1,1) lds=9216
.amdgcn_target "amdgcn-amd-amdhsa--gfx950"
.text
.globl gated_mix__mha_block_cached__sliding_block_cached__decode_kernel
.p2align 8
.type gated_mix__mha_block_cached__sliding_block_cached__decode_kernel,@function
gated_mix__mha_block_cached__sliding_block_cached__decode_kernel:
  s_cmp_ge_u32 s2, 256
  s_cbranch_scc1 L_done
  s_load_dwordx16 s[16:31], s[0:1], 0
  s_load_dwordx8 s[32:39], s[0:1], 64
  s_load_dwordx4 s[40:43], s[0:1], 96
  v_lshrrev_b32 v79, 6, v0
  v_bfe_u32 v76, v0, 6, 2
  v_bfe_u32 v77, v0, 4, 2
  v_and_b32 v78, 15, v0
  v_readfirstlane_b32 s80, v79
  s_and_b32 s78, s2, 7
  s_bfe_u32 s79, s2, 0x30003
  s_lshr_b32 s74, s2, 6
  s_lshr_b32 s90, s78, 1
  s_and_b32 s75, s90, 1
  s_xor_b32 s91, s78, s90
  s_and_b32 s91, s91, 1
  s_and_b32 s90, s90, 2
  s_or_b32 s90, s90, s91
  s_lshl_b32 s72, s90, 1
  s_and_b32 s91, s79, 1
  s_or_b32 s72, s72, s91
  s_lshr_b32 s91, s79, 1
  s_lshl_b32 s91, s91, 3
  s_or_b32 s72, s72, s91
  s_lshl_b32 s92, s74, 5
  s_or_b32 s92, s92, s72
  s_lshl_b32 s76, s92, 1
  s_or_b32 s76, s76, s75
  v_lshrrev_b32 v82, 2, v78
  v_and_b32 v83, 3, v78
  v_lshlrev_b32 v1, 8, v82
  v_lshl_add_u32 v1, v77, 6, v1
  v_lshl_add_u32 v1, v83, 4, v1
  v_and_b32 v2, 63, v0
  v_lshlrev_b32 v2, 4, v2
  v_mov_b32 v6, 0
  s_mov_b32 s47, 0x20000
  s_mov_b32 s51, 0x20000
  s_mov_b32 s55, 0x20000
  s_mov_b32 s59, 0x20000
  s_bitcmp1_b32 s80, 2
  s_cbranch_scc1 L_side
  v_lshl_add_u32 v3, v76, 12, v1
  s_lshl_b32 s92, s92, 21
  s_cmp_eq_u32 s75, 0
  s_cselect_b32 s81, 0, 2080768
  s_mov_b32 s82, 16384
  s_cselect_b32 s82, s82, 4294950912
  s_mov_b32 s98, s81
  s_waitcnt lgkmcnt(0)
  s_add_u32 s44, s18, s92
  s_addc_u32 s45, s19, 0
  s_mov_b32 s46, 2097152
  buffer_load_dwordx4 a[0:3], v3, s[44:47], s81 offen offset:0 nt
  buffer_load_dwordx4 a[4:7], v3, s[44:47], s81 offen offset:1024 nt
  buffer_load_dwordx4 a[8:11], v3, s[44:47], s81 offen offset:2048 nt
  buffer_load_dwordx4 a[12:15], v3, s[44:47], s81 offen offset:3072 nt
  s_add_u32 s81, s81, s82
  buffer_load_dwordx4 a[16:19], v3, s[44:47], s81 offen offset:0 nt
  buffer_load_dwordx4 a[20:23], v3, s[44:47], s81 offen offset:1024 nt
  buffer_load_dwordx4 a[24:27], v3, s[44:47], s81 offen offset:2048 nt
  buffer_load_dwordx4 a[28:31], v3, s[44:47], s81 offen offset:3072 nt
  s_add_u32 s81, s81, s82
  v_lshlrev_b32 v8, 6, v77
  v_lshl_add_u32 v8, v82, 4, v8
  v_and_b32 v84, 1, v78
  v_lshlrev_b32 v84, 4, v84
  v_mov_b32 v85, 0xffff
  v_lshlrev_b32 v85, v84, v85
  v_bfe_u32 v86, v78, 1, 2
  v_cmp_eq_u32 vcc, 0, v86
  s_nop 1
  v_cndmask_b32 v12, 0, v85, vcc
  v_cmp_eq_u32 vcc, 1, v86
  s_nop 1
  v_cndmask_b32 v13, 0, v85, vcc
  v_cmp_eq_u32 vcc, 2, v86
  s_nop 1
  v_cndmask_b32 v14, 0, v85, vcc
  v_cmp_eq_u32 vcc, 3, v86
  s_nop 1
  v_cndmask_b32 v15, 0, v85, vcc
  s_mov_b32 s64, 0x11111111
  s_mov_b32 s65, 0x11111111
  s_mov_b32 s66, 0x22222222
  s_mov_b32 s67, 0x22222222
  s_mov_b32 s68, 0x44444444
  s_mov_b32 s69, 0x44444444
  s_mov_b32 s70, 0x88888888
  s_mov_b32 s71, 0x88888888
  s_mov_b32 s62, 0x3e0293ee
  v_mov_b32 v24, 0
  v_mov_b32 v25, 0
  v_mov_b32 v26, 0
  v_mov_b32 v27, 0
  v_and_b32 v84, 1, v77
  v_lshlrev_b32 v7, 8, v76
  v_lshl_add_u32 v7, v78, 4, v7
  v_lshl_add_u32 v7, v84, 3, v7
  buffer_load_dwordx4 a[32:35], v3, s[44:47], s81 offen offset:0 nt
  buffer_load_dwordx4 a[36:39], v3, s[44:47], s81 offen offset:1024 nt
  buffer_load_dwordx4 a[40:43], v3, s[44:47], s81 offen offset:2048 nt
  buffer_load_dwordx4 a[44:47], v3, s[44:47], s81 offen offset:3072 nt
  s_add_u32 s81, s81, s82
  buffer_load_dwordx4 a[48:51], v3, s[44:47], s81 offen offset:0 nt
  buffer_load_dwordx4 a[52:55], v3, s[44:47], s81 offen offset:1024 nt
  buffer_load_dwordx4 a[56:59], v3, s[44:47], s81 offen offset:2048 nt
  buffer_load_dwordx4 a[60:63], v3, s[44:47], s81 offen offset:3072 nt
  s_add_u32 s81, s81, s82
  buffer_load_dwordx4 a[64:67], v3, s[44:47], s81 offen offset:0 nt
  buffer_load_dwordx4 a[68:71], v3, s[44:47], s81 offen offset:1024 nt
  buffer_load_dwordx4 a[72:75], v3, s[44:47], s81 offen offset:2048 nt
  buffer_load_dwordx4 a[76:79], v3, s[44:47], s81 offen offset:3072 nt
  s_add_u32 s81, s81, s82
  buffer_load_dwordx4 a[80:83], v3, s[44:47], s81 offen offset:0 nt
  buffer_load_dwordx4 a[84:87], v3, s[44:47], s81 offen offset:1024 nt
  buffer_load_dwordx4 a[88:91], v3, s[44:47], s81 offen offset:2048 nt
  buffer_load_dwordx4 a[92:95], v3, s[44:47], s81 offen offset:3072 nt
  s_add_u32 s81, s81, s82
  buffer_load_dwordx4 a[96:99], v3, s[44:47], s81 offen offset:0 nt
  buffer_load_dwordx4 a[100:103], v3, s[44:47], s81 offen offset:1024 nt
  buffer_load_dwordx4 a[104:107], v3, s[44:47], s81 offen offset:2048 nt
  buffer_load_dwordx4 a[108:111], v3, s[44:47], s81 offen offset:3072 nt
  s_add_u32 s81, s81, s82
  buffer_load_dwordx4 a[112:115], v3, s[44:47], s81 offen offset:0 nt
  buffer_load_dwordx4 a[116:119], v3, s[44:47], s81 offen offset:1024 nt
  buffer_load_dwordx4 a[120:123], v3, s[44:47], s81 offen offset:2048 nt
  buffer_load_dwordx4 a[124:127], v3, s[44:47], s81 offen offset:3072 nt
  s_add_u32 s81, s81, s82
  s_add_u32 s48, s20, s92
  s_addc_u32 s49, s21, 0
  s_mov_b32 s50, 2097152
  s_add_u32 s56, s18, s92
  s_addc_u32 s57, s19, 0
  s_mov_b32 s58, 2097152
  v_mov_b32 v4, v3
  v_lshlrev_b32 v11, 6, v82
  v_lshl_add_u32 v11, v76, 4, v11
  v_lshl_add_u32 v11, v77, 2, v11
  v_lshlrev_b32 v10, 2, v76
  v_lshl_add_u32 v2, v76, 12, v2
  v_mov_b32 v52, 0xff800000
  v_mov_b32 v5, 0x10000
  s_mov_b32 s11, 0
  s_barrier
  s_call_b64 s[60:61], L_finq
L_kloop:
  s_waitcnt vmcnt(31)
  v_mfma_f32_16x16x32_bf16 v[28:31], a[0:3], v[36:39], 0
  buffer_load_dwordx4 a[0:3], v3, s[44:47], s81 offen offset:0 nt
  s_waitcnt vmcnt(31)
  v_mfma_f32_16x16x32_bf16 v[28:31], a[4:7], v[40:43], v[28:31]
  buffer_load_dwordx4 a[4:7], v3, s[44:47], s81 offen offset:1024 nt
  s_waitcnt vmcnt(31)
  v_mfma_f32_16x16x32_bf16 v[28:31], a[8:11], v[44:47], v[28:31]
  buffer_load_dwordx4 a[8:11], v3, s[44:47], s81 offen offset:2048 nt
  v_add_f32_dpp v121, v32, v35 row_ror:12 row_mask:0xf bank_mask:0x8
  s_waitcnt vmcnt(31)
  v_mfma_f32_16x16x32_bf16 v[28:31], a[12:15], v[48:51], v[28:31]
  v_add_f32_dpp v121, v33, v121 row_ror:8 row_mask:0xf bank_mask:0x8
  buffer_load_dwordx4 a[12:15], v3, s[44:47], s81 offen offset:3072 nt
  s_add_u32 s81, s81, s82
  v_add_f32_dpp v121, v34, v121 row_ror:4 row_mask:0xf bank_mask:0x8
  s_waitcnt vmcnt(31)
  v_mfma_f32_16x16x32_bf16 v[32:35], a[16:19], v[36:39], 0
  buffer_load_dwordx4 a[16:19], v3, s[44:47], s81 offen offset:0 nt
  v_mov_b32 v108, v110
  v_mov_b32 v109, v111
  v_mov_b32 v110, v112
  v_mov_b32 v111, v113
  v_mov_b32 v112, v114
  v_mov_b32 v113, v115
  v_mov_b32 v114, v116
  v_mov_b32 v115, v117
  v_mov_b32 v116, v118
  v_mov_b32 v117, v119
  v_mov_b32 v118, v120
  v_mov_b32 v119, v121
  s_waitcnt vmcnt(31)
  v_mfma_f32_16x16x32_bf16 v[32:35], a[20:23], v[40:43], v[32:35]
  buffer_load_dwordx4 a[20:23], v3, s[44:47], s81 offen offset:1024 nt
  s_waitcnt vmcnt(31)
  v_mfma_f32_16x16x32_bf16 v[32:35], a[24:27], v[44:47], v[32:35]
  buffer_load_dwordx4 a[24:27], v3, s[44:47], s81 offen offset:2048 nt
  v_add_f32_dpp v120, v29, v28 row_ror:12 row_mask:0xf bank_mask:0x1
  s_waitcnt vmcnt(31)
  v_mfma_f32_16x16x32_bf16 v[32:35], a[28:31], v[48:51], v[32:35]
  v_add_f32_dpp v120, v30, v120 row_ror:8 row_mask:0xf bank_mask:0x1
  buffer_load_dwordx4 a[28:31], v3, s[44:47], s81 offen offset:3072 nt
  s_add_u32 s81, s81, s82
  v_add_f32_dpp v120, v31, v120 row_ror:4 row_mask:0xf bank_mask:0x1
  s_waitcnt vmcnt(31)
  v_mfma_f32_16x16x32_bf16 v[28:31], a[32:35], v[36:39], 0
  buffer_load_dwordx4 a[32:35], v3, s[44:47], s81 offen offset:0 nt
  s_waitcnt vmcnt(31)
  v_mfma_f32_16x16x32_bf16 v[28:31], a[36:39], v[40:43], v[28:31]
  buffer_load_dwordx4 a[36:39], v3, s[44:47], s81 offen offset:1024 nt
  s_waitcnt vmcnt(31)
  v_mfma_f32_16x16x32_bf16 v[28:31], a[40:43], v[44:47], v[28:31]
  buffer_load_dwordx4 a[40:43], v3, s[44:47], s81 offen offset:2048 nt
  v_add_f32_dpp v120, v32, v33 row_ror:4 row_mask:0xf bank_mask:0x2
  s_waitcnt vmcnt(31)
  v_mfma_f32_16x16x32_bf16 v[28:31], a[44:47], v[48:51], v[28:31]
  v_add_f32_dpp v120, v34, v120 row_ror:12 row_mask:0xf bank_mask:0x2
  buffer_load_dwordx4 a[44:47], v3, s[44:47], s81 offen offset:3072 nt
  s_add_u32 s81, s81, s82
  v_add_f32_dpp v120, v35, v120 row_ror:8 row_mask:0xf bank_mask:0x2
  s_waitcnt vmcnt(31)
  v_mfma_f32_16x16x32_bf16 v[32:35], a[48:51], v[36:39], 0
  buffer_load_dwordx4 a[48:51], v3, s[44:47], s81 offen offset:0 nt
  s_waitcnt vmcnt(31)
  v_mfma_f32_16x16x32_bf16 v[32:35], a[52:55], v[40:43], v[32:35]
  buffer_load_dwordx4 a[52:55], v3, s[44:47], s81 offen offset:1024 nt
  s_waitcnt vmcnt(31)
  v_mfma_f32_16x16x32_bf16 v[32:35], a[56:59], v[44:47], v[32:35]
  buffer_load_dwordx4 a[56:59], v3, s[44:47], s81 offen offset:2048 nt
  v_add_f32_dpp v120, v28, v30 row_ror:8 row_mask:0xf bank_mask:0x4
  s_waitcnt vmcnt(31)
  v_mfma_f32_16x16x32_bf16 v[32:35], a[60:63], v[48:51], v[32:35]
  v_add_f32_dpp v120, v29, v120 row_ror:4 row_mask:0xf bank_mask:0x4
  buffer_load_dwordx4 a[60:63], v3, s[44:47], s81 offen offset:3072 nt
  s_add_u32 s81, s81, s82
  v_add_f32_dpp v120, v31, v120 row_ror:12 row_mask:0xf bank_mask:0x4
  s_waitcnt vmcnt(31)
  v_mfma_f32_16x16x32_bf16 v[28:31], a[64:67], v[36:39], 0
  buffer_load_dwordx4 a[64:67], v3, s[44:47], s81 offen offset:0 nt
  s_waitcnt vmcnt(31)
  v_mfma_f32_16x16x32_bf16 v[28:31], a[68:71], v[40:43], v[28:31]
  buffer_load_dwordx4 a[68:71], v3, s[44:47], s81 offen offset:1024 nt
  s_waitcnt vmcnt(31)
  v_mfma_f32_16x16x32_bf16 v[28:31], a[72:75], v[44:47], v[28:31]
  buffer_load_dwordx4 a[72:75], v3, s[44:47], s81 offen offset:2048 nt
  v_add_f32_dpp v120, v32, v35 row_ror:12 row_mask:0xf bank_mask:0x8
  s_waitcnt vmcnt(31)
  v_mfma_f32_16x16x32_bf16 v[28:31], a[76:79], v[48:51], v[28:31]
  v_add_f32_dpp v120, v33, v120 row_ror:8 row_mask:0xf bank_mask:0x8
  buffer_load_dwordx4 a[76:79], v3, s[44:47], s81 offen offset:3072 nt
  s_add_u32 s81, s81, s82
  v_add_f32_dpp v120, v34, v120 row_ror:4 row_mask:0xf bank_mask:0x8
  s_waitcnt vmcnt(31)
  v_mfma_f32_16x16x32_bf16 v[32:35], a[80:83], v[36:39], 0
  buffer_load_dwordx4 a[80:83], v3, s[44:47], s81 offen offset:0 nt
  s_waitcnt vmcnt(31)
  v_mfma_f32_16x16x32_bf16 v[32:35], a[84:87], v[40:43], v[32:35]
  buffer_load_dwordx4 a[84:87], v3, s[44:47], s81 offen offset:1024 nt
  s_waitcnt vmcnt(31)
  v_mfma_f32_16x16x32_bf16 v[32:35], a[88:91], v[44:47], v[32:35]
  buffer_load_dwordx4 a[88:91], v3, s[44:47], s81 offen offset:2048 nt
  v_add_f32_dpp v121, v29, v28 row_ror:12 row_mask:0xf bank_mask:0x1
  s_waitcnt vmcnt(31)
  v_mfma_f32_16x16x32_bf16 v[32:35], a[92:95], v[48:51], v[32:35]
  v_add_f32_dpp v121, v30, v121 row_ror:8 row_mask:0xf bank_mask:0x1
  buffer_load_dwordx4 a[92:95], v3, s[44:47], s81 offen offset:3072 nt
  s_add_u32 s81, s81, s82
  v_add_f32_dpp v121, v31, v121 row_ror:4 row_mask:0xf bank_mask:0x1
  s_waitcnt vmcnt(31)
  v_mfma_f32_16x16x32_bf16 v[28:31], a[96:99], v[36:39], 0
  buffer_load_dwordx4 a[96:99], v3, s[44:47], s81 offen offset:0 nt
  s_waitcnt vmcnt(31)
  v_mfma_f32_16x16x32_bf16 v[28:31], a[100:103], v[40:43], v[28:31]
  buffer_load_dwordx4 a[100:103], v3, s[44:47], s81 offen offset:1024 nt
  s_waitcnt vmcnt(31)
  v_mfma_f32_16x16x32_bf16 v[28:31], a[104:107], v[44:47], v[28:31]
  buffer_load_dwordx4 a[104:107], v3, s[44:47], s81 offen offset:2048 nt
  v_add_f32_dpp v121, v32, v33 row_ror:4 row_mask:0xf bank_mask:0x2
  s_waitcnt vmcnt(31)
  v_mfma_f32_16x16x32_bf16 v[28:31], a[108:111], v[48:51], v[28:31]
  v_add_f32_dpp v121, v34, v121 row_ror:12 row_mask:0xf bank_mask:0x2
  buffer_load_dwordx4 a[108:111], v3, s[44:47], s81 offen offset:3072 nt
  s_add_u32 s81, s81, s82
  v_add_f32_dpp v121, v35, v121 row_ror:8 row_mask:0xf bank_mask:0x2
  s_waitcnt vmcnt(31)
  v_mfma_f32_16x16x32_bf16 v[32:35], a[112:115], v[36:39], 0
  buffer_load_dwordx4 a[112:115], v3, s[44:47], s81 offen offset:0 nt
  s_waitcnt vmcnt(31)
  v_mfma_f32_16x16x32_bf16 v[32:35], a[116:119], v[40:43], v[32:35]
  buffer_load_dwordx4 a[116:119], v3, s[44:47], s81 offen offset:1024 nt
  s_waitcnt vmcnt(31)
  v_mfma_f32_16x16x32_bf16 v[32:35], a[120:123], v[44:47], v[32:35]
  buffer_load_dwordx4 a[120:123], v3, s[44:47], s81 offen offset:2048 nt
  v_add_f32_dpp v121, v28, v30 row_ror:8 row_mask:0xf bank_mask:0x4
  s_waitcnt vmcnt(31)
  v_mfma_f32_16x16x32_bf16 v[32:35], a[124:127], v[48:51], v[32:35]
  v_add_f32_dpp v121, v29, v121 row_ror:4 row_mask:0xf bank_mask:0x4
  buffer_load_dwordx4 a[124:127], v3, s[44:47], s81 offen offset:3072 nt
  s_add_u32 s81, s81, s82
  v_add_f32_dpp v121, v31, v121 row_ror:12 row_mask:0xf bank_mask:0x4
  s_add_u32 s11, s11, 1
  s_cmp_lt_u32 s11, 6
  s_cbranch_scc1 L_kloop
  s_mov_b32 s44, s48
  s_mov_b32 s45, s49
  v_mov_b32 v3, v2
  s_cmp_eq_u32 s11, 6
  s_cselect_b32 s81, s98, s81
  s_cbranch_scc1 L_kloop
  v_add_f32_dpp v121, v32, v35 row_ror:12 row_mask:0xf bank_mask:0x8
  s_nop 1
  v_add_f32_dpp v121, v33, v121 row_ror:8 row_mask:0xf bank_mask:0x8
  s_nop 1
  v_add_f32_dpp v121, v34, v121 row_ror:4 row_mask:0xf bank_mask:0x8
  s_nop 1
  v_max_f32 v58, v108, v109
  v_max3_f32 v58, v58, v110, v111
  v_max3_f32 v58, v58, v112, v113
  v_max3_f32 v58, v58, v114, v115
  v_max3_f32 v58, v58, v116, v117
  v_max3_f32 v58, v58, v118, v119
  v_max3_f32 v58, v58, v120, v121
  s_nop 1
  v_max_f32_dpp v58, v58, v58 row_ror:8 row_mask:0xf bank_mask:0xf
  s_nop 1
  v_max_f32_dpp v58, v58, v58 row_ror:4 row_mask:0xf bank_mask:0xf
  s_nop 1
  v_max_f32_dpp v58, v58, v58 row_ror:2 row_mask:0xf bank_mask:0xf
  s_nop 1
  v_max_f32_dpp v58, v58, v58 row_ror:1 row_mask:0xf bank_mask:0xf
  s_nop 0
  v_readlane_b32 s91, v58, 0
  v_readlane_b32 s92, v58, 16
  v_readlane_b32 s93, v58, 32
  v_readlane_b32 s94, v58, 48
  v_max_f32 v58, s91, v58
  v_max_f32 v58, s92, v58
  v_max_f32 v58, s93, v58
  v_max_f32 v58, s94, v58
  v_mul_f32 v59, s62, v58
  v_fma_f32 v108, v108, s62, -v59
  v_fma_f32 v109, v109, s62, -v59
  v_fma_f32 v110, v110, s62, -v59
  v_fma_f32 v111, v111, s62, -v59
  v_fma_f32 v112, v112, s62, -v59
  v_fma_f32 v113, v113, s62, -v59
  v_fma_f32 v114, v114, s62, -v59
  v_fma_f32 v115, v115, s62, -v59
  v_fma_f32 v116, v116, s62, -v59
  v_fma_f32 v117, v117, s62, -v59
  v_fma_f32 v118, v118, s62, -v59
  v_fma_f32 v119, v119, s62, -v59
  v_fma_f32 v120, v120, s62, -v59
  v_fma_f32 v121, v121, s62, -v59
  v_exp_f32 v108, v108
  v_exp_f32 v109, v109
  v_exp_f32 v110, v110
  v_exp_f32 v111, v111
  v_exp_f32 v112, v112
  v_exp_f32 v113, v113
  v_exp_f32 v114, v114
  v_exp_f32 v115, v115
  v_exp_f32 v116, v116
  v_exp_f32 v117, v117
  v_exp_f32 v118, v118
  v_exp_f32 v119, v119
  v_exp_f32 v120, v120
  v_exp_f32 v121, v121
  v_add_f32 v60, v108, v109
  v_add_f32 v60, v60, v110
  v_add_f32 v60, v60, v111
  v_add_f32 v60, v60, v112
  v_add_f32 v60, v60, v113
  v_add_f32 v60, v60, v114
  v_add_f32 v60, v60, v115
  v_add_f32 v60, v60, v116
  v_add_f32 v60, v60, v117
  v_add_f32 v60, v60, v118
  v_add_f32 v60, v60, v119
  v_add_f32 v60, v60, v120
  v_add_f32 v60, v60, v121
  v_cvt_pk_bf16_f32 v108, v108, v108
  v_cvt_pk_bf16_f32 v109, v109, v109
  v_cvt_pk_bf16_f32 v110, v110, v110
  v_add_f32_dpp v60, v60, v60 row_ror:8 row_mask:0xf bank_mask:0xf
  v_cvt_pk_bf16_f32 v111, v111, v111
  v_cvt_pk_bf16_f32 v112, v112, v112
  v_cvt_pk_bf16_f32 v113, v113, v113
  v_add_f32_dpp v60, v60, v60 row_ror:4 row_mask:0xf bank_mask:0xf
  v_cvt_pk_bf16_f32 v114, v114, v114
  v_cvt_pk_bf16_f32 v115, v115, v115
  v_cvt_pk_bf16_f32 v116, v116, v116
  v_cvt_pk_bf16_f32 v117, v117, v117
  v_cvt_pk_bf16_f32 v118, v118, v118
  v_cvt_pk_bf16_f32 v119, v119, v119
  v_cvt_pk_bf16_f32 v120, v120, v120
  v_cvt_pk_bf16_f32 v121, v121, v121
  s_mov_b32 s11, 0
  s_mov_b32 s10, 3
  v_mov_b32 v56, 1
  s_ashr_i32 s86, s82, 2
L_vloop:
  v_and_b32_dpp v16, v108, v12 row_newbcast:0 row_mask:0xf bank_mask:0xf
  v_and_b32_dpp v17, v108, v13 row_newbcast:0 row_mask:0xf bank_mask:0xf
  v_and_b32_dpp v18, v108, v14 row_newbcast:0 row_mask:0xf bank_mask:0xf
  v_and_b32_dpp v19, v108, v15 row_newbcast:0 row_mask:0xf bank_mask:0xf
  v_and_b32_dpp v20, v108, v12 row_newbcast:1 row_mask:0xf bank_mask:0xf
  v_and_b32_dpp v21, v108, v13 row_newbcast:1 row_mask:0xf bank_mask:0xf
  v_and_b32_dpp v22, v108, v14 row_newbcast:1 row_mask:0xf bank_mask:0xf
  v_and_b32_dpp v23, v108, v15 row_newbcast:1 row_mask:0xf bank_mask:0xf
  s_waitcnt vmcnt(31)
  v_mfma_f32_16x16x32_bf16 v[24:27], v[16:19], a[0:3], v[24:27]
  buffer_load_dwordx4 a[0:3], v3, s[44:47], s81 offen offset:0 nt
  v_and_b32_dpp v16, v108, v12 row_newbcast:2 row_mask:0xf bank_mask:0xf
  v_and_b32_dpp v17, v108, v13 row_newbcast:2 row_mask:0xf bank_mask:0xf
  v_and_b32_dpp v18, v108, v14 row_newbcast:2 row_mask:0xf bank_mask:0xf
  v_and_b32_dpp v19, v108, v15 row_newbcast:2 row_mask:0xf bank_mask:0xf
  s_waitcnt vmcnt(31)
  v_mfma_f32_16x16x32_bf16 v[24:27], v[20:23], a[4:7], v[24:27]
  buffer_load_dwordx4 a[4:7], v3, s[44:47], s81 offen offset:1024 nt
  v_and_b32_dpp v20, v108, v12 row_newbcast:3 row_mask:0xf bank_mask:0xf
  v_and_b32_dpp v21, v108, v13 row_newbcast:3 row_mask:0xf bank_mask:0xf
  v_and_b32_dpp v22, v108, v14 row_newbcast:3 row_mask:0xf bank_mask:0xf
  v_and_b32_dpp v23, v108, v15 row_newbcast:3 row_mask:0xf bank_mask:0xf
  s_waitcnt vmcnt(31)
  v_mfma_f32_16x16x32_bf16 v[24:27], v[16:19], a[8:11], v[24:27]
  buffer_load_dwordx4 a[8:11], v3, s[44:47], s81 offen offset:2048 nt
  v_and_b32_dpp v16, v108, v12 row_newbcast:4 row_mask:0xf bank_mask:0xf
  v_and_b32_dpp v17, v108, v13 row_newbcast:4 row_mask:0xf bank_mask:0xf
  v_and_b32_dpp v18, v108, v14 row_newbcast:4 row_mask:0xf bank_mask:0xf
  v_and_b32_dpp v19, v108, v15 row_newbcast:4 row_mask:0xf bank_mask:0xf
  s_waitcnt vmcnt(31)
  v_mfma_f32_16x16x32_bf16 v[24:27], v[20:23], a[12:15], v[24:27]
  buffer_load_dwordx4 a[12:15], v3, s[44:47], s81 offen offset:3072 nt
  s_add_u32 s81, s81, s82
  v_and_b32_dpp v20, v108, v12 row_newbcast:5 row_mask:0xf bank_mask:0xf
  v_and_b32_dpp v21, v108, v13 row_newbcast:5 row_mask:0xf bank_mask:0xf
  v_and_b32_dpp v22, v108, v14 row_newbcast:5 row_mask:0xf bank_mask:0xf
  v_and_b32_dpp v23, v108, v15 row_newbcast:5 row_mask:0xf bank_mask:0xf
  s_waitcnt vmcnt(31)
  v_mfma_f32_16x16x32_bf16 v[24:27], v[16:19], a[16:19], v[24:27]
  buffer_load_dwordx4 a[16:19], v3, s[44:47], s81 offen offset:0 nt
  v_and_b32_dpp v16, v108, v12 row_newbcast:6 row_mask:0xf bank_mask:0xf
  v_and_b32_dpp v17, v108, v13 row_newbcast:6 row_mask:0xf bank_mask:0xf
  v_and_b32_dpp v18, v108, v14 row_newbcast:6 row_mask:0xf bank_mask:0xf
  v_and_b32_dpp v19, v108, v15 row_newbcast:6 row_mask:0xf bank_mask:0xf
  s_waitcnt vmcnt(31)
  v_mfma_f32_16x16x32_bf16 v[24:27], v[20:23], a[20:23], v[24:27]
  buffer_load_dwordx4 a[20:23], v3, s[44:47], s81 offen offset:1024 nt
  v_and_b32_dpp v20, v108, v12 row_newbcast:7 row_mask:0xf bank_mask:0xf
  v_and_b32_dpp v21, v108, v13 row_newbcast:7 row_mask:0xf bank_mask:0xf
  v_and_b32_dpp v22, v108, v14 row_newbcast:7 row_mask:0xf bank_mask:0xf
  v_and_b32_dpp v23, v108, v15 row_newbcast:7 row_mask:0xf bank_mask:0xf
  s_waitcnt vmcnt(31)
  v_mfma_f32_16x16x32_bf16 v[24:27], v[16:19], a[24:27], v[24:27]
  buffer_load_dwordx4 a[24:27], v3, s[44:47], s81 offen offset:2048 nt
  s_waitcnt vmcnt(31)
  v_mfma_f32_16x16x32_bf16 v[24:27], v[20:23], a[28:31], v[24:27]
  buffer_load_dwordx4 a[28:31], v3, s[44:47], s81 offen offset:3072 nt
  s_add_u32 s81, s81, s82
  v_and_b32_dpp v16, v108, v12 row_newbcast:8 row_mask:0xf bank_mask:0xf
  v_and_b32_dpp v17, v108, v13 row_newbcast:8 row_mask:0xf bank_mask:0xf
  v_and_b32_dpp v18, v108, v14 row_newbcast:8 row_mask:0xf bank_mask:0xf
  v_and_b32_dpp v19, v108, v15 row_newbcast:8 row_mask:0xf bank_mask:0xf
  v_and_b32_dpp v20, v108, v12 row_newbcast:9 row_mask:0xf bank_mask:0xf
  v_and_b32_dpp v21, v108, v13 row_newbcast:9 row_mask:0xf bank_mask:0xf
  v_and_b32_dpp v22, v108, v14 row_newbcast:9 row_mask:0xf bank_mask:0xf
  v_and_b32_dpp v23, v108, v15 row_newbcast:9 row_mask:0xf bank_mask:0xf
  s_waitcnt vmcnt(31)
  v_mfma_f32_16x16x32_bf16 v[24:27], v[16:19], a[32:35], v[24:27]
  buffer_load_dwordx4 a[32:35], v3, s[44:47], s81 offen offset:0 nt
  v_and_b32_dpp v16, v108, v12 row_newbcast:10 row_mask:0xf bank_mask:0xf
  v_and_b32_dpp v17, v108, v13 row_newbcast:10 row_mask:0xf bank_mask:0xf
  v_and_b32_dpp v18, v108, v14 row_newbcast:10 row_mask:0xf bank_mask:0xf
  v_and_b32_dpp v19, v108, v15 row_newbcast:10 row_mask:0xf bank_mask:0xf
  s_waitcnt vmcnt(31)
  v_mfma_f32_16x16x32_bf16 v[24:27], v[20:23], a[36:39], v[24:27]
  buffer_load_dwordx4 a[36:39], v3, s[44:47], s81 offen offset:1024 nt
  v_and_b32_dpp v20, v108, v12 row_newbcast:11 row_mask:0xf bank_mask:0xf
  v_and_b32_dpp v21, v108, v13 row_newbcast:11 row_mask:0xf bank_mask:0xf
  v_and_b32_dpp v22, v108, v14 row_newbcast:11 row_mask:0xf bank_mask:0xf
  v_and_b32_dpp v23, v108, v15 row_newbcast:11 row_mask:0xf bank_mask:0xf
  s_waitcnt vmcnt(31)
  v_mfma_f32_16x16x32_bf16 v[24:27], v[16:19], a[40:43], v[24:27]
  buffer_load_dwordx4 a[40:43], v3, s[44:47], s81 offen offset:2048 nt
  v_and_b32_dpp v16, v108, v12 row_newbcast:12 row_mask:0xf bank_mask:0xf
  v_and_b32_dpp v17, v108, v13 row_newbcast:12 row_mask:0xf bank_mask:0xf
  v_and_b32_dpp v18, v108, v14 row_newbcast:12 row_mask:0xf bank_mask:0xf
  v_and_b32_dpp v19, v108, v15 row_newbcast:12 row_mask:0xf bank_mask:0xf
  s_waitcnt vmcnt(31)
  v_mfma_f32_16x16x32_bf16 v[24:27], v[20:23], a[44:47], v[24:27]
  buffer_load_dwordx4 a[44:47], v3, s[44:47], s81 offen offset:3072 nt
  s_add_u32 s81, s81, s82
  v_and_b32_dpp v20, v108, v12 row_newbcast:13 row_mask:0xf bank_mask:0xf
  v_and_b32_dpp v21, v108, v13 row_newbcast:13 row_mask:0xf bank_mask:0xf
  v_and_b32_dpp v22, v108, v14 row_newbcast:13 row_mask:0xf bank_mask:0xf
  v_and_b32_dpp v23, v108, v15 row_newbcast:13 row_mask:0xf bank_mask:0xf
  s_waitcnt vmcnt(31)
  v_mfma_f32_16x16x32_bf16 v[24:27], v[16:19], a[48:51], v[24:27]
  buffer_load_dwordx4 a[48:51], v3, s[44:47], s81 offen offset:0 nt
  v_and_b32_dpp v16, v108, v12 row_newbcast:14 row_mask:0xf bank_mask:0xf
  v_and_b32_dpp v17, v108, v13 row_newbcast:14 row_mask:0xf bank_mask:0xf
  v_and_b32_dpp v18, v108, v14 row_newbcast:14 row_mask:0xf bank_mask:0xf
  v_and_b32_dpp v19, v108, v15 row_newbcast:14 row_mask:0xf bank_mask:0xf
  s_waitcnt vmcnt(31)
  v_mfma_f32_16x16x32_bf16 v[24:27], v[20:23], a[52:55], v[24:27]
  buffer_load_dwordx4 a[52:55], v3, s[44:47], s81 offen offset:1024 nt
  v_and_b32_dpp v20, v108, v12 row_newbcast:15 row_mask:0xf bank_mask:0xf
  v_and_b32_dpp v21, v108, v13 row_newbcast:15 row_mask:0xf bank_mask:0xf
  v_and_b32_dpp v22, v108, v14 row_newbcast:15 row_mask:0xf bank_mask:0xf
  v_and_b32_dpp v23, v108, v15 row_newbcast:15 row_mask:0xf bank_mask:0xf
  s_waitcnt vmcnt(31)
  v_mfma_f32_16x16x32_bf16 v[24:27], v[16:19], a[56:59], v[24:27]
  buffer_load_dwordx4 a[56:59], v3, s[44:47], s81 offen offset:2048 nt
  s_waitcnt vmcnt(31)
  v_mfma_f32_16x16x32_bf16 v[24:27], v[20:23], a[60:63], v[24:27]
  buffer_load_dwordx4 a[60:63], v3, s[44:47], s81 offen offset:3072 nt
  s_add_u32 s81, s81, s82
  v_and_b32_dpp v16, v109, v12 row_newbcast:0 row_mask:0xf bank_mask:0xf
  v_and_b32_dpp v17, v109, v13 row_newbcast:0 row_mask:0xf bank_mask:0xf
  v_and_b32_dpp v18, v109, v14 row_newbcast:0 row_mask:0xf bank_mask:0xf
  v_and_b32_dpp v19, v109, v15 row_newbcast:0 row_mask:0xf bank_mask:0xf
  v_and_b32_dpp v20, v109, v12 row_newbcast:1 row_mask:0xf bank_mask:0xf
  v_and_b32_dpp v21, v109, v13 row_newbcast:1 row_mask:0xf bank_mask:0xf
  v_and_b32_dpp v22, v109, v14 row_newbcast:1 row_mask:0xf bank_mask:0xf
  v_and_b32_dpp v23, v109, v15 row_newbcast:1 row_mask:0xf bank_mask:0xf
  s_waitcnt vmcnt(31)
  v_mfma_f32_16x16x32_bf16 v[24:27], v[16:19], a[64:67], v[24:27]
  buffer_load_dwordx4 a[64:67], v3, s[44:47], s81 offen offset:0 nt
  v_and_b32_dpp v16, v109, v12 row_newbcast:2 row_mask:0xf bank_mask:0xf
  v_and_b32_dpp v17, v109, v13 row_newbcast:2 row_mask:0xf bank_mask:0xf
  v_and_b32_dpp v18, v109, v14 row_newbcast:2 row_mask:0xf bank_mask:0xf
  v_and_b32_dpp v19, v109, v15 row_newbcast:2 row_mask:0xf bank_mask:0xf
  s_waitcnt vmcnt(31)
  v_mfma_f32_16x16x32_bf16 v[24:27], v[20:23], a[68:71], v[24:27]
  buffer_load_dwordx4 a[68:71], v3, s[44:47], s81 offen offset:1024 nt
  v_and_b32_dpp v20, v109, v12 row_newbcast:3 row_mask:0xf bank_mask:0xf
  v_and_b32_dpp v21, v109, v13 row_newbcast:3 row_mask:0xf bank_mask:0xf
  v_and_b32_dpp v22, v109, v14 row_newbcast:3 row_mask:0xf bank_mask:0xf
  v_and_b32_dpp v23, v109, v15 row_newbcast:3 row_mask:0xf bank_mask:0xf
  s_waitcnt vmcnt(31)
  v_mfma_f32_16x16x32_bf16 v[24:27], v[16:19], a[72:75], v[24:27]
  buffer_load_dwordx4 a[72:75], v3, s[44:47], s81 offen offset:2048 nt
  v_and_b32_dpp v16, v109, v12 row_newbcast:4 row_mask:0xf bank_mask:0xf
  v_and_b32_dpp v17, v109, v13 row_newbcast:4 row_mask:0xf bank_mask:0xf
  v_and_b32_dpp v18, v109, v14 row_newbcast:4 row_mask:0xf bank_mask:0xf
  v_and_b32_dpp v19, v109, v15 row_newbcast:4 row_mask:0xf bank_mask:0xf
  s_waitcnt vmcnt(31)
  v_mfma_f32_16x16x32_bf16 v[24:27], v[20:23], a[76:79], v[24:27]
  buffer_load_dwordx4 a[76:79], v3, s[44:47], s81 offen offset:3072 nt
  s_add_u32 s81, s81, s82
  v_and_b32_dpp v20, v109, v12 row_newbcast:5 row_mask:0xf bank_mask:0xf
  v_and_b32_dpp v21, v109, v13 row_newbcast:5 row_mask:0xf bank_mask:0xf
  v_and_b32_dpp v22, v109, v14 row_newbcast:5 row_mask:0xf bank_mask:0xf
  v_and_b32_dpp v23, v109, v15 row_newbcast:5 row_mask:0xf bank_mask:0xf
  s_waitcnt vmcnt(31)
  v_mfma_f32_16x16x32_bf16 v[24:27], v[16:19], a[80:83], v[24:27]
  buffer_load_dwordx4 a[80:83], v3, s[44:47], s81 offen offset:0 nt
  v_and_b32_dpp v16, v109, v12 row_newbcast:6 row_mask:0xf bank_mask:0xf
  v_and_b32_dpp v17, v109, v13 row_newbcast:6 row_mask:0xf bank_mask:0xf
  v_and_b32_dpp v18, v109, v14 row_newbcast:6 row_mask:0xf bank_mask:0xf
  v_and_b32_dpp v19, v109, v15 row_newbcast:6 row_mask:0xf bank_mask:0xf
  s_waitcnt vmcnt(31)
  v_mfma_f32_16x16x32_bf16 v[24:27], v[20:23], a[84:87], v[24:27]
  buffer_load_dwordx4 a[84:87], v3, s[44:47], s81 offen offset:1024 nt
  v_and_b32_dpp v20, v109, v12 row_newbcast:7 row_mask:0xf bank_mask:0xf
  v_and_b32_dpp v21, v109, v13 row_newbcast:7 row_mask:0xf bank_mask:0xf
  v_and_b32_dpp v22, v109, v14 row_newbcast:7 row_mask:0xf bank_mask:0xf
  v_and_b32_dpp v23, v109, v15 row_newbcast:7 row_mask:0xf bank_mask:0xf
  s_waitcnt vmcnt(31)
  v_mfma_f32_16x16x32_bf16 v[24:27], v[16:19], a[88:91], v[24:27]
  buffer_load_dwordx4 a[88:91], v3, s[44:47], s81 offen offset:2048 nt
  s_waitcnt vmcnt(31)
  v_mfma_f32_16x16x32_bf16 v[24:27], v[20:23], a[92:95], v[24:27]
  buffer_load_dwordx4 a[92:95], v3, s[44:47], s81 offen offset:3072 nt
  s_add_u32 s81, s81, s82
  v_and_b32_dpp v16, v109, v12 row_newbcast:8 row_mask:0xf bank_mask:0xf
  v_and_b32_dpp v17, v109, v13 row_newbcast:8 row_mask:0xf bank_mask:0xf
  v_and_b32_dpp v18, v109, v14 row_newbcast:8 row_mask:0xf bank_mask:0xf
  v_and_b32_dpp v19, v109, v15 row_newbcast:8 row_mask:0xf bank_mask:0xf
  v_and_b32_dpp v20, v109, v12 row_newbcast:9 row_mask:0xf bank_mask:0xf
  v_and_b32_dpp v21, v109, v13 row_newbcast:9 row_mask:0xf bank_mask:0xf
  v_and_b32_dpp v22, v109, v14 row_newbcast:9 row_mask:0xf bank_mask:0xf
  v_and_b32_dpp v23, v109, v15 row_newbcast:9 row_mask:0xf bank_mask:0xf
  s_waitcnt vmcnt(31)
  v_mfma_f32_16x16x32_bf16 v[24:27], v[16:19], a[96:99], v[24:27]
  buffer_load_dwordx4 a[96:99], v3, s[44:47], s81 offen offset:0 nt
  v_and_b32_dpp v16, v109, v12 row_newbcast:10 row_mask:0xf bank_mask:0xf
  v_and_b32_dpp v17, v109, v13 row_newbcast:10 row_mask:0xf bank_mask:0xf
  v_and_b32_dpp v18, v109, v14 row_newbcast:10 row_mask:0xf bank_mask:0xf
  v_and_b32_dpp v19, v109, v15 row_newbcast:10 row_mask:0xf bank_mask:0xf
  s_waitcnt vmcnt(31)
  v_mfma_f32_16x16x32_bf16 v[24:27], v[20:23], a[100:103], v[24:27]
  buffer_load_dwordx4 a[100:103], v3, s[44:47], s81 offen offset:1024 nt
  v_and_b32_dpp v20, v109, v12 row_newbcast:11 row_mask:0xf bank_mask:0xf
  v_and_b32_dpp v21, v109, v13 row_newbcast:11 row_mask:0xf bank_mask:0xf
  v_and_b32_dpp v22, v109, v14 row_newbcast:11 row_mask:0xf bank_mask:0xf
  v_and_b32_dpp v23, v109, v15 row_newbcast:11 row_mask:0xf bank_mask:0xf
  s_waitcnt vmcnt(31)
  v_mfma_f32_16x16x32_bf16 v[24:27], v[16:19], a[104:107], v[24:27]
  buffer_load_dwordx4 a[104:107], v3, s[44:47], s81 offen offset:2048 nt
  v_and_b32_dpp v16, v109, v12 row_newbcast:12 row_mask:0xf bank_mask:0xf
  v_and_b32_dpp v17, v109, v13 row_newbcast:12 row_mask:0xf bank_mask:0xf
  v_and_b32_dpp v18, v109, v14 row_newbcast:12 row_mask:0xf bank_mask:0xf
  v_and_b32_dpp v19, v109, v15 row_newbcast:12 row_mask:0xf bank_mask:0xf
  s_waitcnt vmcnt(31)
  v_mfma_f32_16x16x32_bf16 v[24:27], v[20:23], a[108:111], v[24:27]
  buffer_load_dwordx4 a[108:111], v3, s[44:47], s81 offen offset:3072 nt
  s_add_u32 s81, s81, s82
  v_and_b32_dpp v20, v109, v12 row_newbcast:13 row_mask:0xf bank_mask:0xf
  v_and_b32_dpp v21, v109, v13 row_newbcast:13 row_mask:0xf bank_mask:0xf
  v_and_b32_dpp v22, v109, v14 row_newbcast:13 row_mask:0xf bank_mask:0xf
  v_and_b32_dpp v23, v109, v15 row_newbcast:13 row_mask:0xf bank_mask:0xf
  s_waitcnt vmcnt(31)
  v_mfma_f32_16x16x32_bf16 v[24:27], v[16:19], a[112:115], v[24:27]
  buffer_load_dwordx4 a[112:115], v3, s[44:47], s81 offen offset:0 nt
  v_and_b32_dpp v16, v109, v12 row_newbcast:14 row_mask:0xf bank_mask:0xf
  v_and_b32_dpp v17, v109, v13 row_newbcast:14 row_mask:0xf bank_mask:0xf
  v_and_b32_dpp v18, v109, v14 row_newbcast:14 row_mask:0xf bank_mask:0xf
  v_and_b32_dpp v19, v109, v15 row_newbcast:14 row_mask:0xf bank_mask:0xf
  s_waitcnt vmcnt(31)
  v_mfma_f32_16x16x32_bf16 v[24:27], v[20:23], a[116:119], v[24:27]
  buffer_load_dwordx4 a[116:119], v3, s[44:47], s81 offen offset:1024 nt
  v_and_b32_dpp v20, v109, v12 row_newbcast:15 row_mask:0xf bank_mask:0xf
  v_and_b32_dpp v21, v109, v13 row_newbcast:15 row_mask:0xf bank_mask:0xf
  v_and_b32_dpp v22, v109, v14 row_newbcast:15 row_mask:0xf bank_mask:0xf
  v_and_b32_dpp v23, v109, v15 row_newbcast:15 row_mask:0xf bank_mask:0xf
  s_waitcnt vmcnt(31)
  v_mfma_f32_16x16x32_bf16 v[24:27], v[16:19], a[120:123], v[24:27]
  buffer_load_dwordx4 a[120:123], v3, s[44:47], s81 offen offset:2048 nt
  s_waitcnt vmcnt(31)
  v_mfma_f32_16x16x32_bf16 v[24:27], v[20:23], a[124:127], v[24:27]
  buffer_load_dwordx4 a[124:127], v3, s[44:47], s81 offen offset:3072 nt
  s_add_u32 s81, s81, s82
  v_mov_b32 v108, v110
  v_mov_b32 v109, v111
  v_mov_b32 v110, v112
  v_mov_b32 v111, v113
  v_mov_b32 v112, v114
  v_mov_b32 v113, v115
  v_mov_b32 v114, v116
  v_mov_b32 v115, v117
  v_mov_b32 v116, v118
  v_mov_b32 v117, v119
  v_mov_b32 v118, v120
  v_mov_b32 v119, v121
  s_add_u32 s11, s11, 1
  s_cmp_lt_u32 s11, 6
  s_cbranch_scc1 L_vloop
  s_mov_b64 exec, 1
  ds_add_u32 v6, v5 offset:8600
  s_mov_b64 exec, -1
  v_and_b32_dpp v16, v108, v12 row_newbcast:0 row_mask:0xf bank_mask:0xf
  v_and_b32_dpp v17, v108, v13 row_newbcast:0 row_mask:0xf bank_mask:0xf
  v_and_b32_dpp v18, v108, v14 row_newbcast:0 row_mask:0xf bank_mask:0xf
  v_and_b32_dpp v19, v108, v15 row_newbcast:0 row_mask:0xf bank_mask:0xf
  v_and_b32_dpp v20, v108, v12 row_newbcast:1 row_mask:0xf bank_mask:0xf
  v_and_b32_dpp v21, v108, v13 row_newbcast:1 row_mask:0xf bank_mask:0xf
  v_and_b32_dpp v22, v108, v14 row_newbcast:1 row_mask:0xf bank_mask:0xf
  v_and_b32_dpp v23, v108, v15 row_newbcast:1 row_mask:0xf bank_mask:0xf
  s_waitcnt vmcnt(31)
  v_mfma_f32_16x16x32_bf16 v[24:27], v[16:19], a[0:3], v[24:27]
  buffer_load_dwordx4 a[0:3], v4, s[56:59], s81 offen offset:0 nt
  v_and_b32_dpp v16, v108, v12 row_newbcast:2 row_mask:0xf bank_mask:0xf
  v_and_b32_dpp v17, v108, v13 row_newbcast:2 row_mask:0xf bank_mask:0xf
  v_and_b32_dpp v18, v108, v14 row_newbcast:2 row_mask:0xf bank_mask:0xf
  v_and_b32_dpp v19, v108, v15 row_newbcast:2 row_mask:0xf bank_mask:0xf
  s_waitcnt vmcnt(31)
  v_mfma_f32_16x16x32_bf16 v[24:27], v[20:23], a[4:7], v[24:27]
  buffer_load_dwordx4 a[4:7], v4, s[56:59], s81 offen offset:1024 nt
  v_and_b32_dpp v20, v108, v12 row_newbcast:3 row_mask:0xf bank_mask:0xf
  v_and_b32_dpp v21, v108, v13 row_newbcast:3 row_mask:0xf bank_mask:0xf
  v_and_b32_dpp v22, v108, v14 row_newbcast:3 row_mask:0xf bank_mask:0xf
  v_and_b32_dpp v23, v108, v15 row_newbcast:3 row_mask:0xf bank_mask:0xf
  s_waitcnt vmcnt(31)
  v_mfma_f32_16x16x32_bf16 v[24:27], v[16:19], a[8:11], v[24:27]
  buffer_load_dwordx4 a[8:11], v4, s[56:59], s81 offen offset:2048 nt
  v_and_b32_dpp v16, v108, v12 row_newbcast:4 row_mask:0xf bank_mask:0xf
  v_and_b32_dpp v17, v108, v13 row_newbcast:4 row_mask:0xf bank_mask:0xf
  v_and_b32_dpp v18, v108, v14 row_newbcast:4 row_mask:0xf bank_mask:0xf
  v_and_b32_dpp v19, v108, v15 row_newbcast:4 row_mask:0xf bank_mask:0xf
  s_waitcnt vmcnt(31)
  v_mfma_f32_16x16x32_bf16 v[24:27], v[20:23], a[12:15], v[24:27]
  buffer_load_dwordx4 a[12:15], v4, s[56:59], s81 offen offset:3072 nt
  v_and_b32_dpp v20, v108, v12 row_newbcast:5 row_mask:0xf bank_mask:0xf
  v_and_b32_dpp v21, v108, v13 row_newbcast:5 row_mask:0xf bank_mask:0xf
  v_and_b32_dpp v22, v108, v14 row_newbcast:5 row_mask:0xf bank_mask:0xf
  v_and_b32_dpp v23, v108, v15 row_newbcast:5 row_mask:0xf bank_mask:0xf
  s_waitcnt vmcnt(31)
  v_mfma_f32_16x16x32_bf16 v[24:27], v[16:19], a[16:19], v[24:27]
  buffer_load_dwordx4 a[16:19], v2, s[48:51], s81 offen offset:0 nt
  v_and_b32_dpp v16, v108, v12 row_newbcast:6 row_mask:0xf bank_mask:0xf
  v_and_b32_dpp v17, v108, v13 row_newbcast:6 row_mask:0xf bank_mask:0xf
  v_and_b32_dpp v18, v108, v14 row_newbcast:6 row_mask:0xf bank_mask:0xf
  v_and_b32_dpp v19, v108, v15 row_newbcast:6 row_mask:0xf bank_mask:0xf
  s_waitcnt vmcnt(31)
  v_mfma_f32_16x16x32_bf16 v[24:27], v[20:23], a[20:23], v[24:27]
  buffer_load_dwordx4 a[20:23], v2, s[48:51], s81 offen offset:1024 nt
  v_and_b32_dpp v20, v108, v12 row_newbcast:7 row_mask:0xf bank_mask:0xf
  v_and_b32_dpp v21, v108, v13 row_newbcast:7 row_mask:0xf bank_mask:0xf
  v_and_b32_dpp v22, v108, v14 row_newbcast:7 row_mask:0xf bank_mask:0xf
  v_and_b32_dpp v23, v108, v15 row_newbcast:7 row_mask:0xf bank_mask:0xf
  s_waitcnt vmcnt(31)
  v_mfma_f32_16x16x32_bf16 v[24:27], v[16:19], a[24:27], v[24:27]
  buffer_load_dwordx4 a[24:27], v2, s[48:51], s81 offen offset:2048 nt
  s_waitcnt vmcnt(31)
  v_mfma_f32_16x16x32_bf16 v[24:27], v[20:23], a[28:31], v[24:27]
  buffer_load_dwordx4 a[28:31], v2, s[48:51], s81 offen offset:3072 nt
  s_add_u32 s81, s81, s82
  s_mov_b64 exec, 1
  ds_add_u32 v6, v5 offset:8600
  s_mov_b64 exec, -1
  v_and_b32_dpp v16, v108, v12 row_newbcast:8 row_mask:0xf bank_mask:0xf
  v_and_b32_dpp v17, v108, v13 row_newbcast:8 row_mask:0xf bank_mask:0xf
  v_and_b32_dpp v18, v108, v14 row_newbcast:8 row_mask:0xf bank_mask:0xf
  v_and_b32_dpp v19, v108, v15 row_newbcast:8 row_mask:0xf bank_mask:0xf
  v_and_b32_dpp v20, v108, v12 row_newbcast:9 row_mask:0xf bank_mask:0xf
  v_and_b32_dpp v21, v108, v13 row_newbcast:9 row_mask:0xf bank_mask:0xf
  v_and_b32_dpp v22, v108, v14 row_newbcast:9 row_mask:0xf bank_mask:0xf
  v_and_b32_dpp v23, v108, v15 row_newbcast:9 row_mask:0xf bank_mask:0xf
  s_waitcnt vmcnt(31)
  v_mfma_f32_16x16x32_bf16 v[24:27], v[16:19], a[32:35], v[24:27]
  buffer_load_dwordx4 a[32:35], v4, s[56:59], s81 offen offset:0 nt
  v_and_b32_dpp v16, v108, v12 row_newbcast:10 row_mask:0xf bank_mask:0xf
  v_and_b32_dpp v17, v108, v13 row_newbcast:10 row_mask:0xf bank_mask:0xf
  v_and_b32_dpp v18, v108, v14 row_newbcast:10 row_mask:0xf bank_mask:0xf
  v_and_b32_dpp v19, v108, v15 row_newbcast:10 row_mask:0xf bank_mask:0xf
  s_waitcnt vmcnt(31)
  v_mfma_f32_16x16x32_bf16 v[24:27], v[20:23], a[36:39], v[24:27]
  buffer_load_dwordx4 a[36:39], v4, s[56:59], s81 offen offset:1024 nt
  v_and_b32_dpp v20, v108, v12 row_newbcast:11 row_mask:0xf bank_mask:0xf
  v_and_b32_dpp v21, v108, v13 row_newbcast:11 row_mask:0xf bank_mask:0xf
  v_and_b32_dpp v22, v108, v14 row_newbcast:11 row_mask:0xf bank_mask:0xf
  v_and_b32_dpp v23, v108, v15 row_newbcast:11 row_mask:0xf bank_mask:0xf
  s_waitcnt vmcnt(31)
  v_mfma_f32_16x16x32_bf16 v[24:27], v[16:19], a[40:43], v[24:27]
  buffer_load_dwordx4 a[40:43], v4, s[56:59], s81 offen offset:2048 nt
  v_and_b32_dpp v16, v108, v12 row_newbcast:12 row_mask:0xf bank_mask:0xf
  v_and_b32_dpp v17, v108, v13 row_newbcast:12 row_mask:0xf bank_mask:0xf
  v_and_b32_dpp v18, v108, v14 row_newbcast:12 row_mask:0xf bank_mask:0xf
  v_and_b32_dpp v19, v108, v15 row_newbcast:12 row_mask:0xf bank_mask:0xf
  s_waitcnt vmcnt(31)
  v_mfma_f32_16x16x32_bf16 v[24:27], v[20:23], a[44:47], v[24:27]
  buffer_load_dwordx4 a[44:47], v4, s[56:59], s81 offen offset:3072 nt
  v_and_b32_dpp v20, v108, v12 row_newbcast:13 row_mask:0xf bank_mask:0xf
  v_and_b32_dpp v21, v108, v13 row_newbcast:13 row_mask:0xf bank_mask:0xf
  v_and_b32_dpp v22, v108, v14 row_newbcast:13 row_mask:0xf bank_mask:0xf
  v_and_b32_dpp v23, v108, v15 row_newbcast:13 row_mask:0xf bank_mask:0xf
  s_waitcnt vmcnt(31)
  v_mfma_f32_16x16x32_bf16 v[24:27], v[16:19], a[48:51], v[24:27]
  buffer_load_dwordx4 a[48:51], v2, s[48:51], s81 offen offset:0 nt
  v_and_b32_dpp v16, v108, v12 row_newbcast:14 row_mask:0xf bank_mask:0xf
  v_and_b32_dpp v17, v108, v13 row_newbcast:14 row_mask:0xf bank_mask:0xf
  v_and_b32_dpp v18, v108, v14 row_newbcast:14 row_mask:0xf bank_mask:0xf
  v_and_b32_dpp v19, v108, v15 row_newbcast:14 row_mask:0xf bank_mask:0xf
  s_waitcnt vmcnt(31)
  v_mfma_f32_16x16x32_bf16 v[24:27], v[20:23], a[52:55], v[24:27]
  buffer_load_dwordx4 a[52:55], v2, s[48:51], s81 offen offset:1024 nt
  v_and_b32_dpp v20, v108, v12 row_newbcast:15 row_mask:0xf bank_mask:0xf
  v_and_b32_dpp v21, v108, v13 row_newbcast:15 row_mask:0xf bank_mask:0xf
  v_and_b32_dpp v22, v108, v14 row_newbcast:15 row_mask:0xf bank_mask:0xf
  v_and_b32_dpp v23, v108, v15 row_newbcast:15 row_mask:0xf bank_mask:0xf
  s_waitcnt vmcnt(31)
  v_mfma_f32_16x16x32_bf16 v[24:27], v[16:19], a[56:59], v[24:27]
  buffer_load_dwordx4 a[56:59], v2, s[48:51], s81 offen offset:2048 nt
  s_waitcnt vmcnt(31)
  v_mfma_f32_16x16x32_bf16 v[24:27], v[20:23], a[60:63], v[24:27]
  buffer_load_dwordx4 a[60:63], v2, s[48:51], s81 offen offset:3072 nt
  s_add_u32 s81, s81, s82
  s_mov_b64 exec, 1
  ds_add_u32 v6, v5 offset:8600
  s_mov_b64 exec, -1
  v_and_b32_dpp v16, v109, v12 row_newbcast:0 row_mask:0xf bank_mask:0xf
  v_and_b32_dpp v17, v109, v13 row_newbcast:0 row_mask:0xf bank_mask:0xf
  v_and_b32_dpp v18, v109, v14 row_newbcast:0 row_mask:0xf bank_mask:0xf
  v_and_b32_dpp v19, v109, v15 row_newbcast:0 row_mask:0xf bank_mask:0xf
  v_and_b32_dpp v20, v109, v12 row_newbcast:1 row_mask:0xf bank_mask:0xf
  v_and_b32_dpp v21, v109, v13 row_newbcast:1 row_mask:0xf bank_mask:0xf
  v_and_b32_dpp v22, v109, v14 row_newbcast:1 row_mask:0xf bank_mask:0xf
  v_and_b32_dpp v23, v109, v15 row_newbcast:1 row_mask:0xf bank_mask:0xf
  s_waitcnt vmcnt(31)
  v_mfma_f32_16x16x32_bf16 v[24:27], v[16:19], a[64:67], v[24:27]
  buffer_load_dwordx4 a[64:67], v4, s[56:59], s81 offen offset:0 nt
  v_and_b32_dpp v16, v109, v12 row_newbcast:2 row_mask:0xf bank_mask:0xf
  v_and_b32_dpp v17, v109, v13 row_newbcast:2 row_mask:0xf bank_mask:0xf
  v_and_b32_dpp v18, v109, v14 row_newbcast:2 row_mask:0xf bank_mask:0xf
  v_and_b32_dpp v19, v109, v15 row_newbcast:2 row_mask:0xf bank_mask:0xf
  s_waitcnt vmcnt(31)
  v_mfma_f32_16x16x32_bf16 v[24:27], v[20:23], a[68:71], v[24:27]
  buffer_load_dwordx4 a[68:71], v4, s[56:59], s81 offen offset:1024 nt
  v_and_b32_dpp v20, v109, v12 row_newbcast:3 row_mask:0xf bank_mask:0xf
  v_and_b32_dpp v21, v109, v13 row_newbcast:3 row_mask:0xf bank_mask:0xf
  v_and_b32_dpp v22, v109, v14 row_newbcast:3 row_mask:0xf bank_mask:0xf
  v_and_b32_dpp v23, v109, v15 row_newbcast:3 row_mask:0xf bank_mask:0xf
  s_waitcnt vmcnt(31)
  v_mfma_f32_16x16x32_bf16 v[24:27], v[16:19], a[72:75], v[24:27]
  buffer_load_dwordx4 a[72:75], v4, s[56:59], s81 offen offset:2048 nt
  v_and_b32_dpp v16, v109, v12 row_newbcast:4 row_mask:0xf bank_mask:0xf
  v_and_b32_dpp v17, v109, v13 row_newbcast:4 row_mask:0xf bank_mask:0xf
  v_and_b32_dpp v18, v109, v14 row_newbcast:4 row_mask:0xf bank_mask:0xf
  v_and_b32_dpp v19, v109, v15 row_newbcast:4 row_mask:0xf bank_mask:0xf
  s_waitcnt vmcnt(31)
  v_mfma_f32_16x16x32_bf16 v[24:27], v[20:23], a[76:79], v[24:27]
  buffer_load_dwordx4 a[76:79], v4, s[56:59], s81 offen offset:3072 nt
  v_and_b32_dpp v20, v109, v12 row_newbcast:5 row_mask:0xf bank_mask:0xf
  v_and_b32_dpp v21, v109, v13 row_newbcast:5 row_mask:0xf bank_mask:0xf
  v_and_b32_dpp v22, v109, v14 row_newbcast:5 row_mask:0xf bank_mask:0xf
  v_and_b32_dpp v23, v109, v15 row_newbcast:5 row_mask:0xf bank_mask:0xf
  s_waitcnt vmcnt(31)
  v_mfma_f32_16x16x32_bf16 v[24:27], v[16:19], a[80:83], v[24:27]
  buffer_load_dwordx4 a[80:83], v2, s[48:51], s81 offen offset:0 nt
  v_and_b32_dpp v16, v109, v12 row_newbcast:6 row_mask:0xf bank_mask:0xf
  v_and_b32_dpp v17, v109, v13 row_newbcast:6 row_mask:0xf bank_mask:0xf
  v_and_b32_dpp v18, v109, v14 row_newbcast:6 row_mask:0xf bank_mask:0xf
  v_and_b32_dpp v19, v109, v15 row_newbcast:6 row_mask:0xf bank_mask:0xf
  s_waitcnt vmcnt(31)
  v_mfma_f32_16x16x32_bf16 v[24:27], v[20:23], a[84:87], v[24:27]
  buffer_load_dwordx4 a[84:87], v2, s[48:51], s81 offen offset:1024 nt
  v_and_b32_dpp v20, v109, v12 row_newbcast:7 row_mask:0xf bank_mask:0xf
  v_and_b32_dpp v21, v109, v13 row_newbcast:7 row_mask:0xf bank_mask:0xf
  v_and_b32_dpp v22, v109, v14 row_newbcast:7 row_mask:0xf bank_mask:0xf
  v_and_b32_dpp v23, v109, v15 row_newbcast:7 row_mask:0xf bank_mask:0xf
  s_waitcnt vmcnt(31)
  v_mfma_f32_16x16x32_bf16 v[24:27], v[16:19], a[88:91], v[24:27]
  buffer_load_dwordx4 a[88:91], v2, s[48:51], s81 offen offset:2048 nt
  s_waitcnt vmcnt(31)
  v_mfma_f32_16x16x32_bf16 v[24:27], v[20:23], a[92:95], v[24:27]
  buffer_load_dwordx4 a[92:95], v2, s[48:51], s81 offen offset:3072 nt
  s_add_u32 s81, s81, s82
  s_mov_b64 exec, 1
  ds_add_u32 v6, v5 offset:8600
  s_mov_b64 exec, -1
  v_and_b32_dpp v16, v109, v12 row_newbcast:8 row_mask:0xf bank_mask:0xf
  v_and_b32_dpp v17, v109, v13 row_newbcast:8 row_mask:0xf bank_mask:0xf
  v_and_b32_dpp v18, v109, v14 row_newbcast:8 row_mask:0xf bank_mask:0xf
  v_and_b32_dpp v19, v109, v15 row_newbcast:8 row_mask:0xf bank_mask:0xf
  v_and_b32_dpp v20, v109, v12 row_newbcast:9 row_mask:0xf bank_mask:0xf
  v_and_b32_dpp v21, v109, v13 row_newbcast:9 row_mask:0xf bank_mask:0xf
  v_and_b32_dpp v22, v109, v14 row_newbcast:9 row_mask:0xf bank_mask:0xf
  v_and_b32_dpp v23, v109, v15 row_newbcast:9 row_mask:0xf bank_mask:0xf
  s_waitcnt vmcnt(31)
  v_mfma_f32_16x16x32_bf16 v[24:27], v[16:19], a[96:99], v[24:27]
  buffer_load_dwordx4 a[96:99], v4, s[56:59], s81 offen offset:0 nt
  v_and_b32_dpp v16, v109, v12 row_newbcast:10 row_mask:0xf bank_mask:0xf
  v_and_b32_dpp v17, v109, v13 row_newbcast:10 row_mask:0xf bank_mask:0xf
  v_and_b32_dpp v18, v109, v14 row_newbcast:10 row_mask:0xf bank_mask:0xf
  v_and_b32_dpp v19, v109, v15 row_newbcast:10 row_mask:0xf bank_mask:0xf
  s_waitcnt vmcnt(31)
  v_mfma_f32_16x16x32_bf16 v[24:27], v[20:23], a[100:103], v[24:27]
  buffer_load_dwordx4 a[100:103], v4, s[56:59], s81 offen offset:1024 nt
  v_and_b32_dpp v20, v109, v12 row_newbcast:11 row_mask:0xf bank_mask:0xf
  v_and_b32_dpp v21, v109, v13 row_newbcast:11 row_mask:0xf bank_mask:0xf
  v_and_b32_dpp v22, v109, v14 row_newbcast:11 row_mask:0xf bank_mask:0xf
  v_and_b32_dpp v23, v109, v15 row_newbcast:11 row_mask:0xf bank_mask:0xf
  s_waitcnt vmcnt(31)
  v_mfma_f32_16x16x32_bf16 v[24:27], v[16:19], a[104:107], v[24:27]
  buffer_load_dwordx4 a[104:107], v4, s[56:59], s81 offen offset:2048 nt
  v_and_b32_dpp v16, v109, v12 row_newbcast:12 row_mask:0xf bank_mask:0xf
  v_and_b32_dpp v17, v109, v13 row_newbcast:12 row_mask:0xf bank_mask:0xf
  v_and_b32_dpp v18, v109, v14 row_newbcast:12 row_mask:0xf bank_mask:0xf
  v_and_b32_dpp v19, v109, v15 row_newbcast:12 row_mask:0xf bank_mask:0xf
  s_waitcnt vmcnt(31)
  v_mfma_f32_16x16x32_bf16 v[24:27], v[20:23], a[108:111], v[24:27]
  buffer_load_dwordx4 a[108:111], v4, s[56:59], s81 offen offset:3072 nt
  v_and_b32_dpp v20, v109, v12 row_newbcast:13 row_mask:0xf bank_mask:0xf
  v_and_b32_dpp v21, v109, v13 row_newbcast:13 row_mask:0xf bank_mask:0xf
  v_and_b32_dpp v22, v109, v14 row_newbcast:13 row_mask:0xf bank_mask:0xf
  v_and_b32_dpp v23, v109, v15 row_newbcast:13 row_mask:0xf bank_mask:0xf
  s_waitcnt vmcnt(31)
  v_mfma_f32_16x16x32_bf16 v[24:27], v[16:19], a[112:115], v[24:27]
  buffer_load_dwordx4 a[112:115], v2, s[48:51], s81 offen offset:0 nt
  v_and_b32_dpp v16, v109, v12 row_newbcast:14 row_mask:0xf bank_mask:0xf
  v_and_b32_dpp v17, v109, v13 row_newbcast:14 row_mask:0xf bank_mask:0xf
  v_and_b32_dpp v18, v109, v14 row_newbcast:14 row_mask:0xf bank_mask:0xf
  v_and_b32_dpp v19, v109, v15 row_newbcast:14 row_mask:0xf bank_mask:0xf
  s_waitcnt vmcnt(31)
  v_mfma_f32_16x16x32_bf16 v[24:27], v[20:23], a[116:119], v[24:27]
  buffer_load_dwordx4 a[116:119], v2, s[48:51], s81 offen offset:1024 nt
  v_and_b32_dpp v20, v109, v12 row_newbcast:15 row_mask:0xf bank_mask:0xf
  v_and_b32_dpp v21, v109, v13 row_newbcast:15 row_mask:0xf bank_mask:0xf
  v_and_b32_dpp v22, v109, v14 row_newbcast:15 row_mask:0xf bank_mask:0xf
  v_and_b32_dpp v23, v109, v15 row_newbcast:15 row_mask:0xf bank_mask:0xf
  s_waitcnt vmcnt(31)
  v_mfma_f32_16x16x32_bf16 v[24:27], v[16:19], a[120:123], v[24:27]
  buffer_load_dwordx4 a[120:123], v2, s[48:51], s81 offen offset:2048 nt
  s_waitcnt vmcnt(31)
  v_mfma_f32_16x16x32_bf16 v[24:27], v[20:23], a[124:127], v[24:27]
  s_mov_b64 exec, 1
  ds_add_rtn_u32 v55, v6, v56 offset:8600
  ds_read_b32 v9, v6 offset:8604
  s_mov_b64 exec, -1
  buffer_load_dwordx4 a[124:127], v2, s[48:51], s81 offen offset:3072 nt
  s_add_u32 s81, s81, s82
  s_mov_b32 s11, 0
  s_mul_i32 s85, s75, 12288
  s_add_u32 s85, s85, s81
  v_mov_b32 v4, v1
  v_and_b32 v2, 0x3ff, v2
L_zloop:
  s_waitcnt lgkmcnt(0)
  v_readfirstlane_b32 s12, v9
  v_readfirstlane_b32 s84, v55
  s_and_b32 s84, s84, 0xffff
  s_mul_i32 s81, s84, s86
  s_add_u32 s81, s81, s85
  s_and_b32 s90, s12, 0xffff
  s_cmp_lt_u32 s84, s90
  s_cbranch_scc1 L_ok0
  s_call_b64 s[60:61], L_slow
  s_cbranch_scc0 L_dr0
L_ok0:
  s_waitcnt vmcnt(31)
  v_mfma_f32_16x16x32_bf16 v[28:31], a[0:3], v[36:39], 0
  buffer_load_dwordx4 a[0:3], v4, s[56:59], s81 offen offset:0 nt
  s_waitcnt vmcnt(31)
  v_mfma_f32_16x16x32_bf16 v[28:31], a[4:7], v[40:43], v[28:31]
  buffer_load_dwordx4 a[4:7], v4, s[56:59], s81 offen offset:1024 nt
  s_waitcnt vmcnt(31)
  v_mfma_f32_16x16x32_bf16 v[28:31], a[8:11], v[44:47], v[28:31]
  buffer_load_dwordx4 a[8:11], v4, s[56:59], s81 offen offset:2048 nt
  s_waitcnt vmcnt(31)
  v_mfma_f32_16x16x32_bf16 v[28:31], a[12:15], v[48:51], v[28:31]
  buffer_load_dwordx4 a[12:15], v4, s[56:59], s81 offen offset:3072 nt
  s_add_u32 s11, s11, 1
  s_nop 5
  v_add_f32_dpp v52, v29, v28 row_ror:12 row_mask:0xf bank_mask:0x1
  s_nop 1
  v_add_f32_dpp v52, v30, v52 row_ror:8 row_mask:0xf bank_mask:0x1
  s_nop 1
  v_add_f32_dpp v52, v31, v52 row_ror:4 row_mask:0xf bank_mask:0x1
  v_cmp_gt_f32 vcc, v52, v58
  v_fma_f32 v53, v52, s62, -v59
  s_cbranch_vccz L_nr0
  s_call_b64 s[60:61], L_resc
L_nr0:
  v_exp_f32 v53, v53
  s_nop 0
  v_cvt_pk_bf16_f32 v54, v53, v53
  v_add_f32 v60, v60, v53
  s_nop 0
  v_and_b32_dpp v16, v54, v12 row_newbcast:0 row_mask:0xf bank_mask:0xf
  v_and_b32_dpp v17, v54, v13 row_newbcast:0 row_mask:0xf bank_mask:0xf
  v_and_b32_dpp v18, v54, v14 row_newbcast:0 row_mask:0xf bank_mask:0xf
  v_and_b32_dpp v19, v54, v15 row_newbcast:0 row_mask:0xf bank_mask:0xf
  v_and_b32_dpp v20, v54, v12 row_newbcast:1 row_mask:0xf bank_mask:0xf
  v_and_b32_dpp v21, v54, v13 row_newbcast:1 row_mask:0xf bank_mask:0xf
  v_and_b32_dpp v22, v54, v14 row_newbcast:1 row_mask:0xf bank_mask:0xf
  v_and_b32_dpp v23, v54, v15 row_newbcast:1 row_mask:0xf bank_mask:0xf
  s_waitcnt vmcnt(31)
  v_mfma_f32_16x16x32_bf16 v[24:27], v[16:19], a[16:19], v[24:27]
  buffer_load_dwordx4 a[16:19], v2, s[48:51], s81 offen offset:0 nt
  v_and_b32_dpp v16, v54, v12 row_newbcast:2 row_mask:0xf bank_mask:0xf
  v_and_b32_dpp v17, v54, v13 row_newbcast:2 row_mask:0xf bank_mask:0xf
  v_and_b32_dpp v18, v54, v14 row_newbcast:2 row_mask:0xf bank_mask:0xf
  v_and_b32_dpp v19, v54, v15 row_newbcast:2 row_mask:0xf bank_mask:0xf
  s_waitcnt vmcnt(31)
  v_mfma_f32_16x16x32_bf16 v[24:27], v[20:23], a[20:23], v[24:27]
  buffer_load_dwordx4 a[20:23], v2, s[48:51], s81 offen offset:1024 nt
  v_and_b32_dpp v20, v54, v12 row_newbcast:3 row_mask:0xf bank_mask:0xf
  v_and_b32_dpp v21, v54, v13 row_newbcast:3 row_mask:0xf bank_mask:0xf
  v_and_b32_dpp v22, v54, v14 row_newbcast:3 row_mask:0xf bank_mask:0xf
  v_and_b32_dpp v23, v54, v15 row_newbcast:3 row_mask:0xf bank_mask:0xf
  s_waitcnt vmcnt(31)
  v_mfma_f32_16x16x32_bf16 v[24:27], v[16:19], a[24:27], v[24:27]
  buffer_load_dwordx4 a[24:27], v2, s[48:51], s81 offen offset:2048 nt
  s_waitcnt vmcnt(31)
  v_mfma_f32_16x16x32_bf16 v[24:27], v[20:23], a[28:31], v[24:27]
  s_mov_b64 exec, 1
  ds_add_rtn_u32 v55, v6, v56 offset:8600
  ds_read_b32 v9, v6 offset:8604
  s_mov_b64 exec, -1
  buffer_load_dwordx4 a[28:31], v2, s[48:51], s81 offen offset:3072 nt
  s_waitcnt lgkmcnt(0)
  v_readfirstlane_b32 s12, v9
  v_readfirstlane_b32 s84, v55
  s_and_b32 s84, s84, 0xffff
  s_mul_i32 s81, s84, s86
  s_add_u32 s81, s81, s85
  s_and_b32 s90, s12, 0xffff
  s_cmp_lt_u32 s84, s90
  s_cbranch_scc1 L_ok1
  s_call_b64 s[60:61], L_slow
  s_cbranch_scc0 L_dr1
L_ok1:
  s_waitcnt vmcnt(31)
  v_mfma_f32_16x16x32_bf16 v[28:31], a[32:35], v[36:39], 0
  buffer_load_dwordx4 a[32:35], v4, s[56:59], s81 offen offset:0 nt
  s_waitcnt vmcnt(31)
  v_mfma_f32_16x16x32_bf16 v[28:31], a[36:39], v[40:43], v[28:31]
  buffer_load_dwordx4 a[36:39], v4, s[56:59], s81 offen offset:1024 nt
  s_waitcnt vmcnt(31)
  v_mfma_f32_16x16x32_bf16 v[28:31], a[40:43], v[44:47], v[28:31]
  buffer_load_dwordx4 a[40:43], v4, s[56:59], s81 offen offset:2048 nt
  s_waitcnt vmcnt(31)
  v_mfma_f32_16x16x32_bf16 v[28:31], a[44:47], v[48:51], v[28:31]
  buffer_load_dwordx4 a[44:47], v4, s[56:59], s81 offen offset:3072 nt
  s_add_u32 s11, s11, 1
  s_nop 5
  v_add_f32_dpp v52, v29, v28 row_ror:12 row_mask:0xf bank_mask:0x1
  s_nop 1
  v_add_f32_dpp v52, v30, v52 row_ror:8 row_mask:0xf bank_mask:0x1
  s_nop 1
  v_add_f32_dpp v52, v31, v52 row_ror:4 row_mask:0xf bank_mask:0x1
  v_cmp_gt_f32 vcc, v52, v58
  v_fma_f32 v53, v52, s62, -v59
  s_cbranch_vccz L_nr1
  s_call_b64 s[60:61], L_resc
L_nr1:
  v_exp_f32 v53, v53
  s_nop 0
  v_cvt_pk_bf16_f32 v54, v53, v53
  v_add_f32 v60, v60, v53
  s_nop 0
  v_and_b32_dpp v16, v54, v12 row_newbcast:0 row_mask:0xf bank_mask:0xf
  v_and_b32_dpp v17, v54, v13 row_newbcast:0 row_mask:0xf bank_mask:0xf
  v_and_b32_dpp v18, v54, v14 row_newbcast:0 row_mask:0xf bank_mask:0xf
  v_and_b32_dpp v19, v54, v15 row_newbcast:0 row_mask:0xf bank_mask:0xf
  v_and_b32_dpp v20, v54, v12 row_newbcast:1 row_mask:0xf bank_mask:0xf
  v_and_b32_dpp v21, v54, v13 row_newbcast:1 row_mask:0xf bank_mask:0xf
  v_and_b32_dpp v22, v54, v14 row_newbcast:1 row_mask:0xf bank_mask:0xf
  v_and_b32_dpp v23, v54, v15 row_newbcast:1 row_mask:0xf bank_mask:0xf
  s_waitcnt vmcnt(31)
  v_mfma_f32_16x16x32_bf16 v[24:27], v[16:19], a[48:51], v[24:27]
  buffer_load_dwordx4 a[48:51], v2, s[48:51], s81 offen offset:0 nt
  v_and_b32_dpp v16, v54, v12 row_newbcast:2 row_mask:0xf bank_mask:0xf
  v_and_b32_dpp v17, v54, v13 row_newbcast:2 row_mask:0xf bank_mask:0xf
  v_and_b32_dpp v18, v54, v14 row_newbcast:2 row_mask:0xf bank_mask:0xf
  v_and_b32_dpp v19, v54, v15 row_newbcast:2 row_mask:0xf bank_mask:0xf
  s_waitcnt vmcnt(31)
  v_mfma_f32_16x16x32_bf16 v[24:27], v[20:23], a[52:55], v[24:27]
  buffer_load_dwordx4 a[52:55], v2, s[48:51], s81 offen offset:1024 nt
  v_and_b32_dpp v20, v54, v12 row_newbcast:3 row_mask:0xf bank_mask:0xf
  v_and_b32_dpp v21, v54, v13 row_newbcast:3 row_mask:0xf bank_mask:0xf
  v_and_b32_dpp v22, v54, v14 row_newbcast:3 row_mask:0xf bank_mask:0xf
  v_and_b32_dpp v23, v54, v15 row_newbcast:3 row_mask:0xf bank_mask:0xf
  s_waitcnt vmcnt(31)
  v_mfma_f32_16x16x32_bf16 v[24:27], v[16:19], a[56:59], v[24:27]
  buffer_load_dwordx4 a[56:59], v2, s[48:51], s81 offen offset:2048 nt
  s_waitcnt vmcnt(31)
  v_mfma_f32_16x16x32_bf16 v[24:27], v[20:23], a[60:63], v[24:27]
  s_mov_b64 exec, 1
  ds_add_rtn_u32 v55, v6, v56 offset:8600
  ds_read_b32 v9, v6 offset:8604
  s_mov_b64 exec, -1
  buffer_load_dwordx4 a[60:63], v2, s[48:51], s81 offen offset:3072 nt
  s_waitcnt lgkmcnt(0)
  v_readfirstlane_b32 s12, v9
  v_readfirstlane_b32 s84, v55
  s_and_b32 s84, s84, 0xffff
  s_mul_i32 s81, s84, s86
  s_add_u32 s81, s81, s85
  s_and_b32 s90, s12, 0xffff
  s_cmp_lt_u32 s84, s90
  s_cbranch_scc1 L_ok2
  s_call_b64 s[60:61], L_slow
  s_cbranch_scc0 L_dr2
L_ok2:
  s_waitcnt vmcnt(31)
  v_mfma_f32_16x16x32_bf16 v[28:31], a[64:67], v[36:39], 0
  buffer_load_dwordx4 a[64:67], v4, s[56:59], s81 offen offset:0 nt
  s_waitcnt vmcnt(31)
  v_mfma_f32_16x16x32_bf16 v[28:31], a[68:71], v[40:43], v[28:31]
  buffer_load_dwordx4 a[68:71], v4, s[56:59], s81 offen offset:1024 nt
  s_waitcnt vmcnt(31)
  v_mfma_f32_16x16x32_bf16 v[28:31], a[72:75], v[44:47], v[28:31]
  buffer_load_dwordx4 a[72:75], v4, s[56:59], s81 offen offset:2048 nt
  s_waitcnt vmcnt(31)
  v_mfma_f32_16x16x32_bf16 v[28:31], a[76:79], v[48:51], v[28:31]
  buffer_load_dwordx4 a[76:79], v4, s[56:59], s81 offen offset:3072 nt
  s_add_u32 s11, s11, 1
  s_nop 5
  v_add_f32_dpp v52, v29, v28 row_ror:12 row_mask:0xf bank_mask:0x1
  s_nop 1
  v_add_f32_dpp v52, v30, v52 row_ror:8 row_mask:0xf bank_mask:0x1
  s_nop 1
  v_add_f32_dpp v52, v31, v52 row_ror:4 row_mask:0xf bank_mask:0x1
  v_cmp_gt_f32 vcc, v52, v58
  v_fma_f32 v53, v52, s62, -v59
  s_cbranch_vccz L_nr2
  s_call_b64 s[60:61], L_resc
L_nr2:
  v_exp_f32 v53, v53
  s_nop 0
  v_cvt_pk_bf16_f32 v54, v53, v53
  v_add_f32 v60, v60, v53
  s_nop 0
  v_and_b32_dpp v16, v54, v12 row_newbcast:0 row_mask:0xf bank_mask:0xf
  v_and_b32_dpp v17, v54, v13 row_newbcast:0 row_mask:0xf bank_mask:0xf
  v_and_b32_dpp v18, v54, v14 row_newbcast:0 row_mask:0xf bank_mask:0xf
  v_and_b32_dpp v19, v54, v15 row_newbcast:0 row_mask:0xf bank_mask:0xf
  v_and_b32_dpp v20, v54, v12 row_newbcast:1 row_mask:0xf bank_mask:0xf
  v_and_b32_dpp v21, v54, v13 row_newbcast:1 row_mask:0xf bank_mask:0xf
  v_and_b32_dpp v22, v54, v14 row_newbcast:1 row_mask:0xf bank_mask:0xf
  v_and_b32_dpp v23, v54, v15 row_newbcast:1 row_mask:0xf bank_mask:0xf
  s_waitcnt vmcnt(31)
  v_mfma_f32_16x16x32_bf16 v[24:27], v[16:19], a[80:83], v[24:27]
  buffer_load_dwordx4 a[80:83], v2, s[48:51], s81 offen offset:0 nt
  v_and_b32_dpp v16, v54, v12 row_newbcast:2 row_mask:0xf bank_mask:0xf
  v_and_b32_dpp v17, v54, v13 row_newbcast:2 row_mask:0xf bank_mask:0xf
  v_and_b32_dpp v18, v54, v14 row_newbcast:2 row_mask:0xf bank_mask:0xf
  v_and_b32_dpp v19, v54, v15 row_newbcast:2 row_mask:0xf bank_mask:0xf
  s_waitcnt vmcnt(31)
  v_mfma_f32_16x16x32_bf16 v[24:27], v[20:23], a[84:87], v[24:27]
  buffer_load_dwordx4 a[84:87], v2, s[48:51], s81 offen offset:1024 nt
  v_and_b32_dpp v20, v54, v12 row_newbcast:3 row_mask:0xf bank_mask:0xf
  v_and_b32_dpp v21, v54, v13 row_newbcast:3 row_mask:0xf bank_mask:0xf
  v_and_b32_dpp v22, v54, v14 row_newbcast:3 row_mask:0xf bank_mask:0xf
  v_and_b32_dpp v23, v54, v15 row_newbcast:3 row_mask:0xf bank_mask:0xf
  s_waitcnt vmcnt(31)
  v_mfma_f32_16x16x32_bf16 v[24:27], v[16:19], a[88:91], v[24:27]
  buffer_load_dwordx4 a[88:91], v2, s[48:51], s81 offen offset:2048 nt
  s_waitcnt vmcnt(31)
  v_mfma_f32_16x16x32_bf16 v[24:27], v[20:23], a[92:95], v[24:27]
  s_mov_b64 exec, 1
  ds_add_rtn_u32 v55, v6, v56 offset:8600
  ds_read_b32 v9, v6 offset:8604
  s_mov_b64 exec, -1
  buffer_load_dwordx4 a[92:95], v2, s[48:51], s81 offen offset:3072 nt
  s_waitcnt lgkmcnt(0)
  v_readfirstlane_b32 s12, v9
  v_readfirstlane_b32 s84, v55
  s_and_b32 s84, s84, 0xffff
  s_mul_i32 s81, s84, s86
  s_add_u32 s81, s81, s85
  s_and_b32 s90, s12, 0xffff
  s_cmp_lt_u32 s84, s90
  s_cbranch_scc1 L_ok3
  s_call_b64 s[60:61], L_slow
  s_cbranch_scc0 L_dr3
L_ok3:
  s_waitcnt vmcnt(31)
  v_mfma_f32_16x16x32_bf16 v[28:31], a[96:99], v[36:39], 0
  buffer_load_dwordx4 a[96:99], v4, s[56:59], s81 offen offset:0 nt
  s_waitcnt vmcnt(31)
  v_mfma_f32_16x16x32_bf16 v[28:31], a[100:103], v[40:43], v[28:31]
  buffer_load_dwordx4 a[100:103], v4, s[56:59], s81 offen offset:1024 nt
  s_waitcnt vmcnt(31)
  v_mfma_f32_16x16x32_bf16 v[28:31], a[104:107], v[44:47], v[28:31]
  buffer_load_dwordx4 a[104:107], v4, s[56:59], s81 offen offset:2048 nt
  s_waitcnt vmcnt(31)
  v_mfma_f32_16x16x32_bf16 v[28:31], a[108:111], v[48:51], v[28:31]
  buffer_load_dwordx4 a[108:111], v4, s[56:59], s81 offen offset:3072 nt
  s_add_u32 s11, s11, 1
  s_nop 5
  v_add_f32_dpp v52, v29, v28 row_ror:12 row_mask:0xf bank_mask:0x1
  s_nop 1
  v_add_f32_dpp v52, v30, v52 row_ror:8 row_mask:0xf bank_mask:0x1
  s_nop 1
  v_add_f32_dpp v52, v31, v52 row_ror:4 row_mask:0xf bank_mask:0x1
  v_cmp_gt_f32 vcc, v52, v58
  v_fma_f32 v53, v52, s62, -v59
  s_cbranch_vccz L_nr3
  s_call_b64 s[60:61], L_resc
L_nr3:
  v_exp_f32 v53, v53
  s_nop 0
  v_cvt_pk_bf16_f32 v54, v53, v53
  v_add_f32 v60, v60, v53
  s_nop 0
  v_and_b32_dpp v16, v54, v12 row_newbcast:0 row_mask:0xf bank_mask:0xf
  v_and_b32_dpp v17, v54, v13 row_newbcast:0 row_mask:0xf bank_mask:0xf
  v_and_b32_dpp v18, v54, v14 row_newbcast:0 row_mask:0xf bank_mask:0xf
  v_and_b32_dpp v19, v54, v15 row_newbcast:0 row_mask:0xf bank_mask:0xf
  v_and_b32_dpp v20, v54, v12 row_newbcast:1 row_mask:0xf bank_mask:0xf
  v_and_b32_dpp v21, v54, v13 row_newbcast:1 row_mask:0xf bank_mask:0xf
  v_and_b32_dpp v22, v54, v14 row_newbcast:1 row_mask:0xf bank_mask:0xf
  v_and_b32_dpp v23, v54, v15 row_newbcast:1 row_mask:0xf bank_mask:0xf
  s_waitcnt vmcnt(31)
  v_mfma_f32_16x16x32_bf16 v[24:27], v[16:19], a[112:115], v[24:27]
  buffer_load_dwordx4 a[112:115], v2, s[48:51], s81 offen offset:0 nt
  v_and_b32_dpp v16, v54, v12 row_newbcast:2 row_mask:0xf bank_mask:0xf
  v_and_b32_dpp v17, v54, v13 row_newbcast:2 row_mask:0xf bank_mask:0xf
  v_and_b32_dpp v18, v54, v14 row_newbcast:2 row_mask:0xf bank_mask:0xf
  v_and_b32_dpp v19, v54, v15 row_newbcast:2 row_mask:0xf bank_mask:0xf
  s_waitcnt vmcnt(31)
  v_mfma_f32_16x16x32_bf16 v[24:27], v[20:23], a[116:119], v[24:27]
  buffer_load_dwordx4 a[116:119], v2, s[48:51], s81 offen offset:1024 nt
  v_and_b32_dpp v20, v54, v12 row_newbcast:3 row_mask:0xf bank_mask:0xf
  v_and_b32_dpp v21, v54, v13 row_newbcast:3 row_mask:0xf bank_mask:0xf
  v_and_b32_dpp v22, v54, v14 row_newbcast:3 row_mask:0xf bank_mask:0xf
  v_and_b32_dpp v23, v54, v15 row_newbcast:3 row_mask:0xf bank_mask:0xf
  s_waitcnt vmcnt(31)
  v_mfma_f32_16x16x32_bf16 v[24:27], v[16:19], a[120:123], v[24:27]
  buffer_load_dwordx4 a[120:123], v2, s[48:51], s81 offen offset:2048 nt
  s_waitcnt vmcnt(31)
  v_mfma_f32_16x16x32_bf16 v[24:27], v[20:23], a[124:127], v[24:27]
  s_mov_b64 exec, 1
  ds_add_rtn_u32 v55, v6, v56 offset:8600
  ds_read_b32 v9, v6 offset:8604
  s_mov_b64 exec, -1
  buffer_load_dwordx4 a[124:127], v2, s[48:51], s81 offen offset:3072 nt
  s_branch L_zloop
L_dr0:
  s_waitcnt vmcnt(28)
  s_cmp_lt_u32 s10, 3
  s_cbranch_scc0 L_dk0
  s_waitcnt vmcnt(20)
  s_cmp_lt_u32 s10, 2
  s_cbranch_scc0 L_dk0
  s_waitcnt vmcnt(12)
  s_cmp_lt_u32 s10, 1
  s_cbranch_scc0 L_dk0
  s_waitcnt vmcnt(4)
L_dk0:
  v_mfma_f32_16x16x32_bf16 v[28:31], a[0:3], v[36:39], 0
  v_mfma_f32_16x16x32_bf16 v[28:31], a[4:7], v[40:43], v[28:31]
  v_mfma_f32_16x16x32_bf16 v[28:31], a[8:11], v[44:47], v[28:31]
  v_mfma_f32_16x16x32_bf16 v[28:31], a[12:15], v[48:51], v[28:31]
  s_nop 7
  v_add_f32_dpp v52, v29, v28 row_ror:12 row_mask:0xf bank_mask:0x1
  s_nop 1
  v_add_f32_dpp v52, v30, v52 row_ror:8 row_mask:0xf bank_mask:0x1
  s_nop 1
  v_add_f32_dpp v52, v31, v52 row_ror:4 row_mask:0xf bank_mask:0x1
  v_cmp_gt_f32 vcc, v52, v58
  v_fma_f32 v53, v52, s62, -v59
  s_cbranch_vccz L_nrd0
  s_call_b64 s[60:61], L_resc
L_nrd0:
  v_exp_f32 v53, v53
  s_nop 0
  v_cvt_pk_bf16_f32 v54, v53, v53
  v_add_f32 v60, v60, v53
  s_nop 0
  v_and_b32_dpp v92, v54, v12 row_newbcast:0 row_mask:0xf bank_mask:0xf
  v_and_b32_dpp v93, v54, v13 row_newbcast:0 row_mask:0xf bank_mask:0xf
  v_and_b32_dpp v94, v54, v14 row_newbcast:0 row_mask:0xf bank_mask:0xf
  v_and_b32_dpp v95, v54, v15 row_newbcast:0 row_mask:0xf bank_mask:0xf
  v_and_b32_dpp v96, v54, v12 row_newbcast:1 row_mask:0xf bank_mask:0xf
  v_and_b32_dpp v97, v54, v13 row_newbcast:1 row_mask:0xf bank_mask:0xf
  v_and_b32_dpp v98, v54, v14 row_newbcast:1 row_mask:0xf bank_mask:0xf
  v_and_b32_dpp v99, v54, v15 row_newbcast:1 row_mask:0xf bank_mask:0xf
  v_and_b32_dpp v100, v54, v12 row_newbcast:2 row_mask:0xf bank_mask:0xf
  v_and_b32_dpp v101, v54, v13 row_newbcast:2 row_mask:0xf bank_mask:0xf
  v_and_b32_dpp v102, v54, v14 row_newbcast:2 row_mask:0xf bank_mask:0xf
  v_and_b32_dpp v103, v54, v15 row_newbcast:2 row_mask:0xf bank_mask:0xf
  v_and_b32_dpp v104, v54, v12 row_newbcast:3 row_mask:0xf bank_mask:0xf
  v_and_b32_dpp v105, v54, v13 row_newbcast:3 row_mask:0xf bank_mask:0xf
  v_and_b32_dpp v106, v54, v14 row_newbcast:3 row_mask:0xf bank_mask:0xf
  v_and_b32_dpp v107, v54, v15 row_newbcast:3 row_mask:0xf bank_mask:0xf
  s_waitcnt vmcnt(24)
  s_cmp_lt_u32 s10, 3
  s_cbranch_scc0 L_dv0
  s_waitcnt vmcnt(16)
  s_cmp_lt_u32 s10, 2
  s_cbranch_scc0 L_dv0
  s_waitcnt vmcnt(8)
  s_cmp_lt_u32 s10, 1
  s_cbranch_scc0 L_dv0
  s_waitcnt vmcnt(0)
L_dv0:
  v_mfma_f32_16x16x32_bf16 v[24:27], v[92:95], a[16:19], v[24:27]
  v_mfma_f32_16x16x32_bf16 v[24:27], v[96:99], a[20:23], v[24:27]
  v_mfma_f32_16x16x32_bf16 v[24:27], v[100:103], a[24:27], v[24:27]
  v_mfma_f32_16x16x32_bf16 v[24:27], v[104:107], a[28:31], v[24:27]
  s_sub_u32 s10, s10, 1
  s_cbranch_scc1 L_mdone
L_dr1:
  s_waitcnt vmcnt(28)
  s_cmp_lt_u32 s10, 3
  s_cbranch_scc0 L_dk1
  s_waitcnt vmcnt(20)
  s_cmp_lt_u32 s10, 2
  s_cbranch_scc0 L_dk1
  s_waitcnt vmcnt(12)
  s_cmp_lt_u32 s10, 1
  s_cbranch_scc0 L_dk1
  s_waitcnt vmcnt(4)
L_dk1:
  v_mfma_f32_16x16x32_bf16 v[28:31], a[32:35], v[36:39], 0
  v_mfma_f32_16x16x32_bf16 v[28:31], a[36:39], v[40:43], v[28:31]
  v_mfma_f32_16x16x32_bf16 v[28:31], a[40:43], v[44:47], v[28:31]
  v_mfma_f32_16x16x32_bf16 v[28:31], a[44:47], v[48:51], v[28:31]
  s_nop 7
  v_add_f32_dpp v52, v29, v28 row_ror:12 row_mask:0xf bank_mask:0x1
  s_nop 1
  v_add_f32_dpp v52, v30, v52 row_ror:8 row_mask:0xf bank_mask:0x1
  s_nop 1
  v_add_f32_dpp v52, v31, v52 row_ror:4 row_mask:0xf bank_mask:0x1
  v_cmp_gt_f32 vcc, v52, v58
  v_fma_f32 v53, v52, s62, -v59
  s_cbranch_vccz L_nrd1
  s_call_b64 s[60:61], L_resc
L_nrd1:
  v_exp_f32 v53, v53
  s_nop 0
  v_cvt_pk_bf16_f32 v54, v53, v53
  v_add_f32 v60, v60, v53
  s_nop 0
  v_and_b32_dpp v92, v54, v12 row_newbcast:0 row_mask:0xf bank_mask:0xf
  v_and_b32_dpp v93, v54, v13 row_newbcast:0 row_mask:0xf bank_mask:0xf
  v_and_b32_dpp v94, v54, v14 row_newbcast:0 row_mask:0xf bank_mask:0xf
  v_and_b32_dpp v95, v54, v15 row_newbcast:0 row_mask:0xf bank_mask:0xf
  v_and_b32_dpp v96, v54, v12 row_newbcast:1 row_mask:0xf bank_mask:0xf
  v_and_b32_dpp v97, v54, v13 row_newbcast:1 row_mask:0xf bank_mask:0xf
  v_and_b32_dpp v98, v54, v14 row_newbcast:1 row_mask:0xf bank_mask:0xf
  v_and_b32_dpp v99, v54, v15 row_newbcast:1 row_mask:0xf bank_mask:0xf
  v_and_b32_dpp v100, v54, v12 row_newbcast:2 row_mask:0xf bank_mask:0xf
  v_and_b32_dpp v101, v54, v13 row_newbcast:2 row_mask:0xf bank_mask:0xf
  v_and_b32_dpp v102, v54, v14 row_newbcast:2 row_mask:0xf bank_mask:0xf
  v_and_b32_dpp v103, v54, v15 row_newbcast:2 row_mask:0xf bank_mask:0xf
  v_and_b32_dpp v104, v54, v12 row_newbcast:3 row_mask:0xf bank_mask:0xf
  v_and_b32_dpp v105, v54, v13 row_newbcast:3 row_mask:0xf bank_mask:0xf
  v_and_b32_dpp v106, v54, v14 row_newbcast:3 row_mask:0xf bank_mask:0xf
  v_and_b32_dpp v107, v54, v15 row_newbcast:3 row_mask:0xf bank_mask:0xf
  s_waitcnt vmcnt(24)
  s_cmp_lt_u32 s10, 3
  s_cbranch_scc0 L_dv1
  s_waitcnt vmcnt(16)
  s_cmp_lt_u32 s10, 2
  s_cbranch_scc0 L_dv1
  s_waitcnt vmcnt(8)
  s_cmp_lt_u32 s10, 1
  s_cbranch_scc0 L_dv1
  s_waitcnt vmcnt(0)
L_dv1:
  v_mfma_f32_16x16x32_bf16 v[24:27], v[92:95], a[48:51], v[24:27]
  v_mfma_f32_16x16x32_bf16 v[24:27], v[96:99], a[52:55], v[24:27]
  v_mfma_f32_16x16x32_bf16 v[24:27], v[100:103], a[56:59], v[24:27]
  v_mfma_f32_16x16x32_bf16 v[24:27], v[104:107], a[60:63], v[24:27]
  s_sub_u32 s10, s10, 1
  s_cbranch_scc1 L_mdone
L_dr2:
  s_waitcnt vmcnt(28)
  s_cmp_lt_u32 s10, 3
  s_cbranch_scc0 L_dk2
  s_waitcnt vmcnt(20)
  s_cmp_lt_u32 s10, 2
  s_cbranch_scc0 L_dk2
  s_waitcnt vmcnt(12)
  s_cmp_lt_u32 s10, 1
  s_cbranch_scc0 L_dk2
  s_waitcnt vmcnt(4)
L_dk2:
  v_mfma_f32_16x16x32_bf16 v[28:31], a[64:67], v[36:39], 0
  v_mfma_f32_16x16x32_bf16 v[28:31], a[68:71], v[40:43], v[28:31]
  v_mfma_f32_16x16x32_bf16 v[28:31], a[72:75], v[44:47], v[28:31]
  v_mfma_f32_16x16x32_bf16 v[28:31], a[76:79], v[48:51], v[28:31]
  s_nop 7
  v_add_f32_dpp v52, v29, v28 row_ror:12 row_mask:0xf bank_mask:0x1
  s_nop 1
  v_add_f32_dpp v52, v30, v52 row_ror:8 row_mask:0xf bank_mask:0x1
  s_nop 1
  v_add_f32_dpp v52, v31, v52 row_ror:4 row_mask:0xf bank_mask:0x1
  v_cmp_gt_f32 vcc, v52, v58
  v_fma_f32 v53, v52, s62, -v59
  s_cbranch_vccz L_nrd2
  s_call_b64 s[60:61], L_resc
L_nrd2:
  v_exp_f32 v53, v53
  s_nop 0
  v_cvt_pk_bf16_f32 v54, v53, v53
  v_add_f32 v60, v60, v53
  s_nop 0
  v_and_b32_dpp v92, v54, v12 row_newbcast:0 row_mask:0xf bank_mask:0xf
  v_and_b32_dpp v93, v54, v13 row_newbcast:0 row_mask:0xf bank_mask:0xf
  v_and_b32_dpp v94, v54, v14 row_newbcast:0 row_mask:0xf bank_mask:0xf
  v_and_b32_dpp v95, v54, v15 row_newbcast:0 row_mask:0xf bank_mask:0xf
  v_and_b32_dpp v96, v54, v12 row_newbcast:1 row_mask:0xf bank_mask:0xf
  v_and_b32_dpp v97, v54, v13 row_newbcast:1 row_mask:0xf bank_mask:0xf
  v_and_b32_dpp v98, v54, v14 row_newbcast:1 row_mask:0xf bank_mask:0xf
  v_and_b32_dpp v99, v54, v15 row_newbcast:1 row_mask:0xf bank_mask:0xf
  v_and_b32_dpp v100, v54, v12 row_newbcast:2 row_mask:0xf bank_mask:0xf
  v_and_b32_dpp v101, v54, v13 row_newbcast:2 row_mask:0xf bank_mask:0xf
  v_and_b32_dpp v102, v54, v14 row_newbcast:2 row_mask:0xf bank_mask:0xf
  v_and_b32_dpp v103, v54, v15 row_newbcast:2 row_mask:0xf bank_mask:0xf
  v_and_b32_dpp v104, v54, v12 row_newbcast:3 row_mask:0xf bank_mask:0xf
  v_and_b32_dpp v105, v54, v13 row_newbcast:3 row_mask:0xf bank_mask:0xf
  v_and_b32_dpp v106, v54, v14 row_newbcast:3 row_mask:0xf bank_mask:0xf
  v_and_b32_dpp v107, v54, v15 row_newbcast:3 row_mask:0xf bank_mask:0xf
  s_waitcnt vmcnt(24)
  s_cmp_lt_u32 s10, 3
  s_cbranch_scc0 L_dv2
  s_waitcnt vmcnt(16)
  s_cmp_lt_u32 s10, 2
  s_cbranch_scc0 L_dv2
  s_waitcnt vmcnt(8)
  s_cmp_lt_u32 s10, 1
  s_cbranch_scc0 L_dv2
  s_waitcnt vmcnt(0)
L_dv2:
  v_mfma_f32_16x16x32_bf16 v[24:27], v[92:95], a[80:83], v[24:27]
  v_mfma_f32_16x16x32_bf16 v[24:27], v[96:99], a[84:87], v[24:27]
  v_mfma_f32_16x16x32_bf16 v[24:27], v[100:103], a[88:91], v[24:27]
  v_mfma_f32_16x16x32_bf16 v[24:27], v[104:107], a[92:95], v[24:27]
  s_sub_u32 s10, s10, 1
  s_cbranch_scc1 L_mdone
L_dr3:
  s_waitcnt vmcnt(28)
  s_cmp_lt_u32 s10, 3
  s_cbranch_scc0 L_dk3
  s_waitcnt vmcnt(20)
  s_cmp_lt_u32 s10, 2
  s_cbranch_scc0 L_dk3
  s_waitcnt vmcnt(12)
  s_cmp_lt_u32 s10, 1
  s_cbranch_scc0 L_dk3
  s_waitcnt vmcnt(4)
L_dk3:
  v_mfma_f32_16x16x32_bf16 v[28:31], a[96:99], v[36:39], 0
  v_mfma_f32_16x16x32_bf16 v[28:31], a[100:103], v[40:43], v[28:31]
  v_mfma_f32_16x16x32_bf16 v[28:31], a[104:107], v[44:47], v[28:31]
  v_mfma_f32_16x16x32_bf16 v[28:31], a[108:111], v[48:51], v[28:31]
  s_nop 7
  v_add_f32_dpp v52, v29, v28 row_ror:12 row_mask:0xf bank_mask:0x1
  s_nop 1
  v_add_f32_dpp v52, v30, v52 row_ror:8 row_mask:0xf bank_mask:0x1
  s_nop 1
  v_add_f32_dpp v52, v31, v52 row_ror:4 row_mask:0xf bank_mask:0x1
  v_cmp_gt_f32 vcc, v52, v58
  v_fma_f32 v53, v52, s62, -v59
  s_cbranch_vccz L_nrd3
  s_call_b64 s[60:61], L_resc
L_nrd3:
  v_exp_f32 v53, v53
  s_nop 0
  v_cvt_pk_bf16_f32 v54, v53, v53
  v_add_f32 v60, v60, v53
  s_nop 0
  v_and_b32_dpp v92, v54, v12 row_newbcast:0 row_mask:0xf bank_mask:0xf
  v_and_b32_dpp v93, v54, v13 row_newbcast:0 row_mask:0xf bank_mask:0xf
  v_and_b32_dpp v94, v54, v14 row_newbcast:0 row_mask:0xf bank_mask:0xf
  v_and_b32_dpp v95, v54, v15 row_newbcast:0 row_mask:0xf bank_mask:0xf
  v_and_b32_dpp v96, v54, v12 row_newbcast:1 row_mask:0xf bank_mask:0xf
  v_and_b32_dpp v97, v54, v13 row_newbcast:1 row_mask:0xf bank_mask:0xf
  v_and_b32_dpp v98, v54, v14 row_newbcast:1 row_mask:0xf bank_mask:0xf
  v_and_b32_dpp v99, v54, v15 row_newbcast:1 row_mask:0xf bank_mask:0xf
  v_and_b32_dpp v100, v54, v12 row_newbcast:2 row_mask:0xf bank_mask:0xf
  v_and_b32_dpp v101, v54, v13 row_newbcast:2 row_mask:0xf bank_mask:0xf
  v_and_b32_dpp v102, v54, v14 row_newbcast:2 row_mask:0xf bank_mask:0xf
  v_and_b32_dpp v103, v54, v15 row_newbcast:2 row_mask:0xf bank_mask:0xf
  v_and_b32_dpp v104, v54, v12 row_newbcast:3 row_mask:0xf bank_mask:0xf
  v_and_b32_dpp v105, v54, v13 row_newbcast:3 row_mask:0xf bank_mask:0xf
  v_and_b32_dpp v106, v54, v14 row_newbcast:3 row_mask:0xf bank_mask:0xf
  v_and_b32_dpp v107, v54, v15 row_newbcast:3 row_mask:0xf bank_mask:0xf
  s_waitcnt vmcnt(24)
  s_cmp_lt_u32 s10, 3
  s_cbranch_scc0 L_dv3
  s_waitcnt vmcnt(16)
  s_cmp_lt_u32 s10, 2
  s_cbranch_scc0 L_dv3
  s_waitcnt vmcnt(8)
  s_cmp_lt_u32 s10, 1
  s_cbranch_scc0 L_dv3
  s_waitcnt vmcnt(0)
L_dv3:
  v_mfma_f32_16x16x32_bf16 v[24:27], v[92:95], a[112:115], v[24:27]
  v_mfma_f32_16x16x32_bf16 v[24:27], v[96:99], a[116:119], v[24:27]
  v_mfma_f32_16x16x32_bf16 v[24:27], v[100:103], a[120:123], v[24:27]
  v_mfma_f32_16x16x32_bf16 v[24:27], v[104:107], a[124:127], v[24:27]
  s_sub_u32 s10, s10, 1
  s_cbranch_scc0 L_dr0
L_mdone:
  v_add_f32_dpp v60, v60, v60 quad_perm:[1,0,3,2] row_mask:0xf bank_mask:0xf
  ds_write_b32 v10, v59 offset:8576
  s_nop 0
  v_add_f32_dpp v60, v60, v60 quad_perm:[2,3,0,1] row_mask:0xf bank_mask:0xf
  ds_write_b32 v11, v60 offset:7424
  s_nop 0
  v_cvt_pk_bf16_f32 v24, v24, v25
  v_cvt_pk_bf16_f32 v25, v26, v27
  ds_write_b64 v7, v[24:25] offset:6144
  s_waitcnt lgkmcnt(0)
  s_barrier
L_done:
  s_endpgm
L_slow:
  s_mov_b32 s91, 0x400000
L_sl_loop:
  s_bitcmp0_b32 s12, 18
  s_cbranch_scc0 L_sl_fin
  s_sub_u32 s91, s91, 1
  s_cmp_lg_u32 s91, 0
  s_cbranch_scc0 L_sl_fin
  ds_read_b32 v9, v6 offset:8604
  s_waitcnt lgkmcnt(0)
  v_readfirstlane_b32 s12, v9
  s_and_b32 s90, s12, 0xffff
  s_cmp_lt_u32 s84, s90
  s_cbranch_scc0 L_sl_loop
L_sl_fin:
  s_setpc_b64 s[60:61]
L_resc:
  v_max_f32 v58, v58, v52
  s_nop 1
  v_max_f32_dpp v58, v58, v58 row_ror:8 row_mask:0xf bank_mask:0xf
  s_nop 1
  v_max_f32_dpp v58, v58, v58 row_ror:4 row_mask:0xf bank_mask:0xf
  s_nop 1
  v_max_f32_dpp v58, v58, v58 row_ror:2 row_mask:0xf bank_mask:0xf
  s_nop 1
  v_max_f32_dpp v58, v58, v58 row_ror:1 row_mask:0xf bank_mask:0xf
  s_nop 0
  v_readlane_b32 s91, v58, 0
  v_readlane_b32 s92, v58, 16
  v_readlane_b32 s93, v58, 32
  v_readlane_b32 s94, v58, 48
  v_max_f32 v58, s91, v58
  v_max_f32 v58, s92, v58
  v_max_f32 v58, s93, v58
  v_max_f32 v58, s94, v58
  v_mul_f32 v76, s62, v58
  v_sub_f32 v77, v59, v76
  v_exp_f32 v77, v77
  v_mov_b32 v59, v76
  v_fma_f32 v53, v52, s62, -v59
  v_mul_f32 v24, v77, v24
  v_mul_f32 v25, v77, v25
  v_mul_f32 v26, v77, v26
  v_mul_f32 v27, v77, v27
  v_mul_f32 v60, v77, v60
  s_setpc_b64 s[60:61]
L_finq:
  ds_read_b128 v[84:87], v8
  s_waitcnt lgkmcnt(0)
  v_cndmask_b32_e64 v36, 0, v84, s[64:65]
  v_cndmask_b32_e64 v37, 0, v85, s[64:65]
  v_cndmask_b32_e64 v38, 0, v86, s[64:65]
  v_cndmask_b32_e64 v39, 0, v87, s[64:65]
  v_cndmask_b32_e64 v40, 0, v84, s[66:67]
  v_cndmask_b32_e64 v41, 0, v85, s[66:67]
  v_cndmask_b32_e64 v42, 0, v86, s[66:67]
  v_cndmask_b32_e64 v43, 0, v87, s[66:67]
  v_cndmask_b32_e64 v44, 0, v84, s[68:69]
  v_cndmask_b32_e64 v45, 0, v85, s[68:69]
  v_cndmask_b32_e64 v46, 0, v86, s[68:69]
  v_cndmask_b32_e64 v47, 0, v87, s[68:69]
  v_cndmask_b32_e64 v48, 0, v84, s[70:71]
  v_cndmask_b32_e64 v49, 0, v85, s[70:71]
  v_cndmask_b32_e64 v50, 0, v86, s[70:71]
  v_cndmask_b32_e64 v51, 0, v87, s[70:71]
  s_nop 1
  s_setpc_b64 s[60:61]
L_side:
  s_and_b32 s80, s80, 3
  s_setprio 1
  v_bfe_u32 v81, v0, 3, 3
  v_and_b32 v3, 0x70, v2
  v_lshl_add_u32 v3, v81, 17, v3
  v_lshlrev_b32 v81, 5, v81
  v_lshl_add_u32 v80, v78, 2, v77
  s_lshl_b32 s93, s74, 10
  s_and_b32 s90, s79, 3
  s_lshl_b32 s73, s78, 2
  s_or_b32 s73, s73, s90
  s_lshl_b32 s77, s74, 5
  s_or_b32 s77, s77, s73
  s_lshl_b32 s77, s77, 1
  s_lshr_b32 s90, s79, 2
  s_or_b32 s77, s77, s90
  s_lshl_b32 s83, s74, 3
  s_or_b32 s83, s83, s78
  s_lshl_b32 s83, s83, 21
  s_lshl_b32 s90, s90, 18
  s_add_u32 s83, s83, s90
  s_add_u32 s83, s83, 1572864
  s_and_b32 s95, s80, 1
  s_cmp_lt_u32 s80, 2
  s_cselect_b32 s90, s76, s77
  s_bfe_u32 s11, s90, 0x50001
  s_and_b32 s10, s90, 1
  s_and_b32 s90, s90, 63
  s_lshl_b32 s90, s90, 7
  s_lshl_b32 s91, s74, 20
  s_or_b32 s90, s90, s91
  s_lshl_b32 s91, s95, 11
  s_lshl_b32 s92, s74, 8
  s_or_b32 s91, s91, s92
  s_lshr_b32 s92, s80, 1
  s_lshl_b32 s92, s92, 5
  s_or_b32 s92, s92, s11
  s_lshl1_add_u32 s14, s92, s95
  s_lshl_b32 s14, s14, 8
  s_add_u32 s14, s14, 3145728
  s_mov_b32 s46, 1040512
  s_mov_b32 s50, 4096
  s_mov_b32 s54, 4194304
  s_mov_b32 s81, 8192
  s_cmp_lt_u32 s80, 2
  s_waitcnt lgkmcnt(0)
  s_cselect_b32 s44, s22, s32
  s_cselect_b32 s45, s23, s33
  s_mov_b32 s48, s16
  s_mov_b32 s49, s17
  s_add_u32 s44, s44, s90
  s_addc_u32 s45, s45, 0
  buffer_load_dwordx4 v[108:111], v81, s[48:51], s91 offen offset:0
  buffer_load_dwordx4 v[112:115], v81, s[48:51], s91 offen offset:16
  buffer_load_dwordx4 v[116:119], v81, s[48:51], s91 offen offset:1024
  buffer_load_dwordx4 v[120:123], v81, s[48:51], s91 offen offset:1040
  s_mov_b32 s52, s42
  s_mov_b32 s53, s43
  buffer_load_dwordx4 a[0:3], v3, s[44:47], 0 offen
  buffer_load_dwordx4 a[4:7], v3, s[44:47], s81 offen
  s_add_u32 s81, s81, 8192
  buffer_load_dwordx4 a[8:11], v3, s[44:47], s81 offen
  s_add_u32 s81, s81, 8192
  buffer_load_dwordx4 a[12:15], v3, s[44:47], s81 offen
  s_add_u32 s81, s81, 8192
  buffer_load_dwordx4 a[16:19], v3, s[44:47], s81 offen
  s_add_u32 s81, s81, 8192
  buffer_load_dwordx4 a[20:23], v3, s[44:47], s81 offen
  s_add_u32 s81, s81, 8192
  buffer_load_dwordx4 a[24:27], v3, s[44:47], s81 offen
  s_add_u32 s81, s81, 8192
  buffer_load_dwordx4 a[28:31], v3, s[44:47], s81 offen
  s_add_u32 s81, s81, 8192
  buffer_load_dwordx4 a[32:35], v3, s[44:47], s81 offen
  s_add_u32 s81, s81, 8192
  buffer_load_dwordx4 a[36:39], v3, s[44:47], s81 offen
  s_add_u32 s81, s81, 8192
  buffer_load_dwordx4 a[40:43], v3, s[44:47], s81 offen
  s_add_u32 s81, s81, 8192
  buffer_load_dwordx4 a[44:47], v3, s[44:47], s81 offen
  s_add_u32 s81, s81, 8192
  buffer_load_dwordx4 a[48:51], v3, s[44:47], s81 offen
  s_add_u32 s81, s81, 8192
  buffer_load_dwordx4 a[52:55], v3, s[44:47], s81 offen
  s_add_u32 s81, s81, 8192
  buffer_load_dwordx4 a[56:59], v3, s[44:47], s81 offen
  s_add_u32 s81, s81, 8192
  buffer_load_dwordx4 a[60:63], v3, s[44:47], s81 offen
  s_add_u32 s81, s81, 8192
  buffer_load_dwordx4 v[124:127], v6, s[52:55], s14 offen sc1
  s_mov_b32 s89, 0x40000000
  s_lshl_b32 s92, s92, 13
  s_add_u32 s92, s92, 2097152
  s_lshl1_add_u32 s12, s91, s92
  s_lshl_b32 s90, s10, 8
  s_add_u32 s12, s12, s90
  s_lshl_b32 s13, s74, 11
  s_add_u32 s13, s13, s92
  s_or_b32 s90, s10, s74
  s_and_b32 s90, s90, 1
  s_cselect_b32 s14, s89, s14
  s_lshr_b32 s90, s74, 1
  s_xor_b32 s10, s90, s80
  s_lshr_b32 s63, s76, 1
  s_mul_i32 s63, s63, 256
  s_add_u32 s63, s63, 1114112
  s_cmp_eq_u32 s10, 0
  s_cselect_b32 s90, s63, s89
  buffer_load_dword v64, v6, s[52:55], s90 offen sc1
  v_lshlrev_b32 v8, 6, v77
  v_lshl_add_u32 v8, v82, 4, v8
  v_and_b32 v84, 1, v78
  v_lshlrev_b32 v84, 4, v84
  v_mov_b32 v85, 0xffff
  v_lshlrev_b32 v85, v84, v85
  v_bfe_u32 v86, v78, 1, 2
  v_cmp_eq_u32 vcc, 0, v86
  s_nop 1
  v_cndmask_b32 v12, 0, v85, vcc
  v_cmp_eq_u32 vcc, 1, v86
  s_nop 1
  v_cndmask_b32 v13, 0, v85, vcc
  v_cmp_eq_u32 vcc, 2, v86
  s_nop 1
  v_cndmask_b32 v14, 0, v85, vcc
  v_cmp_eq_u32 vcc, 3, v86
  s_nop 1
  v_cndmask_b32 v15, 0, v85, vcc
  s_mov_b32 s64, 0x11111111
  s_mov_b32 s65, 0x11111111
  s_mov_b32 s66, 0x22222222
  s_mov_b32 s67, 0x22222222
  s_mov_b32 s68, 0x44444444
  s_mov_b32 s69, 0x44444444
  s_mov_b32 s70, 0x88888888
  s_mov_b32 s71, 0x88888888
  s_mov_b32 s62, 0x3e0293ee
  v_mov_b32 v24, 0
  v_mov_b32 v25, 0
  v_mov_b32 v26, 0
  v_mov_b32 v27, 0
  v_and_b32 v84, 1, v77
  v_lshlrev_b32 v7, 8, v76
  v_lshl_add_u32 v7, v78, 4, v7
  v_lshl_add_u32 v7, v84, 3, v7
  v_lshlrev_b32 v7, 1, v7
  v_mov_b32 v11, v7
  v_add_u32 v7, 4096, v7
  v_lshl_add_u32 v10, v76, 2, v77
  v_lshlrev_b32 v10, 2, v10
  v_mov_b32 v69, v2
  v_lshl_add_u32 v1, v76, 10, v1
  v_lshl_add_u32 v2, v76, 10, v2
  v_lshlrev_b32 v4, 10, v77
  v_lshl_add_u32 v4, v76, 8, v4
  v_lshl_add_u32 v4, v78, 4, v4
  v_add_u32 v8, 2048, v8
  v_lshlrev_b32 v9, 2, v80
  v_add_u32 v9, 4096, v9
  ds_write_b128 v6, v[24:27] offset:8592
  v_lshrrev_b32 v85, 2, v69
  ds_write_b32 v85, v6 offset:7168
  s_mov_b32 s87, 0
  s_mov_b32 s44, s36
  s_mov_b32 s45, s37
  s_mov_b32 s46, 1024
  s_mov_b32 s90, 0x01000100
  s_mov_b32 s91, 0x03020302
  v_mov_b32 v84, 0x0c0c0c0c
  v_bfi_b32 v36, v12, s90, v84
  v_bfi_b32 v37, v13, s90, v84
  v_bfi_b32 v38, v14, s90, v84
  v_bfi_b32 v39, v15, s90, v84
  v_bfi_b32 v40, v12, s91, v84
  v_bfi_b32 v41, v13, s91, v84
  v_bfi_b32 v42, v14, s91, v84
  v_bfi_b32 v43, v15, s91, v84
  v_and_b32 v87, 0x1ff, v11
  v_lshrrev_b32 v84, 1, v77
  v_lshl_add_u32 v87, v84, 11, v87
  v_and_b32 v84, 31, v0
  v_bfe_u32 v85, v0, 5, 1
  v_lshl_add_u32 v84, v84, 1, v85
  v_lshrrev_b32 v85, 1, v76
  v_lshl_add_u32 v84, v85, 9, v84
  v_lshlrev_b32 v84, 2, v84
  s_movk_i32 s90, 0xfc00
  s_waitcnt vmcnt(18)
  v_perm_b32 v16, v108, v108, v36
  v_perm_b32 v17, v108, v108, v37
  v_perm_b32 v18, v108, v108, v38
  v_perm_b32 v19, v108, v108, v39
  v_perm_b32 v20, v116, v116, v36
  v_perm_b32 v21, v116, v116, v37
  v_perm_b32 v22, v116, v116, v38
  v_perm_b32 v23, v116, v116, v39
  s_waitcnt vmcnt(17)
  v_mfma_f32_16x16x32_bf16 v[24:27], v[16:19], a[0:3], 0
  v_perm_b32 v16, v108, v108, v40
  v_perm_b32 v17, v108, v108, v41
  v_perm_b32 v18, v108, v108, v42
  v_perm_b32 v19, v108, v108, v43
  v_mfma_f32_16x16x32_bf16 v[28:31], v[20:23], a[0:3], 0
  v_perm_b32 v20, v116, v116, v40
  v_perm_b32 v21, v116, v116, v41
  v_perm_b32 v22, v116, v116, v42
  v_perm_b32 v23, v116, v116, v43
  s_waitcnt vmcnt(16)
  v_mfma_f32_16x16x32_bf16 v[24:27], v[16:19], a[4:7], v[24:27]
  v_perm_b32 v16, v109, v109, v36
  v_perm_b32 v17, v109, v109, v37
  v_perm_b32 v18, v109, v109, v38
  v_perm_b32 v19, v109, v109, v39
  v_mfma_f32_16x16x32_bf16 v[28:31], v[20:23], a[4:7], v[28:31]
  v_perm_b32 v20, v117, v117, v36
  v_perm_b32 v21, v117, v117, v37
  v_perm_b32 v22, v117, v117, v38
  v_perm_b32 v23, v117, v117, v39
  s_waitcnt vmcnt(15)
  v_mfma_f32_16x16x32_bf16 v[24:27], v[16:19], a[8:11], v[24:27]
  v_perm_b32 v16, v109, v109, v40
  v_perm_b32 v17, v109, v109, v41
  v_perm_b32 v18, v109, v109, v42
  v_perm_b32 v19, v109, v109, v43
  v_mfma_f32_16x16x32_bf16 v[28:31], v[20:23], a[8:11], v[28:31]
  v_perm_b32 v20, v117, v117, v40
  v_perm_b32 v21, v117, v117, v41
  v_perm_b32 v22, v117, v117, v42
  v_perm_b32 v23, v117, v117, v43
  s_waitcnt vmcnt(14)
  v_mfma_f32_16x16x32_bf16 v[24:27], v[16:19], a[12:15], v[24:27]
  v_perm_b32 v16, v110, v110, v36
  v_perm_b32 v17, v110, v110, v37
  v_perm_b32 v18, v110, v110, v38
  v_perm_b32 v19, v110, v110, v39
  v_mfma_f32_16x16x32_bf16 v[28:31], v[20:23], a[12:15], v[28:31]
  v_perm_b32 v20, v118, v118, v36
  v_perm_b32 v21, v118, v118, v37
  v_perm_b32 v22, v118, v118, v38
  v_perm_b32 v23, v118, v118, v39
  s_waitcnt vmcnt(13)
  v_mfma_f32_16x16x32_bf16 v[24:27], v[16:19], a[16:19], v[24:27]
  v_perm_b32 v16, v110, v110, v40
  v_perm_b32 v17, v110, v110, v41
  v_perm_b32 v18, v110, v110, v42
  v_perm_b32 v19, v110, v110, v43
  v_mfma_f32_16x16x32_bf16 v[28:31], v[20:23], a[16:19], v[28:31]
  v_perm_b32 v20, v118, v118, v40
  v_perm_b32 v21, v118, v118, v41
  v_perm_b32 v22, v118, v118, v42
  v_perm_b32 v23, v118, v118, v43
  s_waitcnt vmcnt(12)
  v_mfma_f32_16x16x32_bf16 v[24:27], v[16:19], a[20:23], v[24:27]
  v_perm_b32 v16, v111, v111, v36
  v_perm_b32 v17, v111, v111, v37
  v_perm_b32 v18, v111, v111, v38
  v_perm_b32 v19, v111, v111, v39
  v_mfma_f32_16x16x32_bf16 v[28:31], v[20:23], a[20:23], v[28:31]
  v_perm_b32 v20, v119, v119, v36
  v_perm_b32 v21, v119, v119, v37
  v_perm_b32 v22, v119, v119, v38
  v_perm_b32 v23, v119, v119, v39
  s_waitcnt vmcnt(11)
  v_mfma_f32_16x16x32_bf16 v[24:27], v[16:19], a[24:27], v[24:27]
  v_perm_b32 v16, v111, v111, v40
  v_perm_b32 v17, v111, v111, v41
  v_perm_b32 v18, v111, v111, v42
  v_perm_b32 v19, v111, v111, v43
  v_mfma_f32_16x16x32_bf16 v[28:31], v[20:23], a[24:27], v[28:31]
  v_perm_b32 v20, v119, v119, v40
  v_perm_b32 v21, v119, v119, v41
  v_perm_b32 v22, v119, v119, v42
  v_perm_b32 v23, v119, v119, v43
  s_waitcnt vmcnt(10)
  v_mfma_f32_16x16x32_bf16 v[24:27], v[16:19], a[28:31], v[24:27]
  v_perm_b32 v16, v112, v112, v36
  v_perm_b32 v17, v112, v112, v37
  v_perm_b32 v18, v112, v112, v38
  v_perm_b32 v19, v112, v112, v39
  v_mfma_f32_16x16x32_bf16 v[28:31], v[20:23], a[28:31], v[28:31]
  v_perm_b32 v20, v120, v120, v36
  v_perm_b32 v21, v120, v120, v37
  v_perm_b32 v22, v120, v120, v38
  v_perm_b32 v23, v120, v120, v39
  s_waitcnt vmcnt(9)
  v_mfma_f32_16x16x32_bf16 v[24:27], v[16:19], a[32:35], v[24:27]
  v_perm_b32 v16, v112, v112, v40
  v_perm_b32 v17, v112, v112, v41
  v_perm_b32 v18, v112, v112, v42
  v_perm_b32 v19, v112, v112, v43
  v_mfma_f32_16x16x32_bf16 v[28:31], v[20:23], a[32:35], v[28:31]
  v_perm_b32 v20, v120, v120, v40
  v_perm_b32 v21, v120, v120, v41
  v_perm_b32 v22, v120, v120, v42
  v_perm_b32 v23, v120, v120, v43
  s_waitcnt vmcnt(8)
  v_mfma_f32_16x16x32_bf16 v[24:27], v[16:19], a[36:39], v[24:27]
  v_perm_b32 v16, v113, v113, v36
  v_perm_b32 v17, v113, v113, v37
  v_perm_b32 v18, v113, v113, v38
  v_perm_b32 v19, v113, v113, v39
  v_mfma_f32_16x16x32_bf16 v[28:31], v[20:23], a[36:39], v[28:31]
  v_perm_b32 v20, v121, v121, v36
  v_perm_b32 v21, v121, v121, v37
  v_perm_b32 v22, v121, v121, v38
  v_perm_b32 v23, v121, v121, v39
  s_waitcnt vmcnt(7)
  v_mfma_f32_16x16x32_bf16 v[24:27], v[16:19], a[40:43], v[24:27]
  v_perm_b32 v16, v113, v113, v40
  v_perm_b32 v17, v113, v113, v41
  v_perm_b32 v18, v113, v113, v42
  v_perm_b32 v19, v113, v113, v43
  v_mfma_f32_16x16x32_bf16 v[28:31], v[20:23], a[40:43], v[28:31]
  v_perm_b32 v20, v121, v121, v40
  v_perm_b32 v21, v121, v121, v41
  v_perm_b32 v22, v121, v121, v42
  v_perm_b32 v23, v121, v121, v43
  s_waitcnt vmcnt(6)
  v_mfma_f32_16x16x32_bf16 v[24:27], v[16:19], a[44:47], v[24:27]
  v_perm_b32 v16, v114, v114, v36
  v_perm_b32 v17, v114, v114, v37
  v_perm_b32 v18, v114, v114, v38
  v_perm_b32 v19, v114, v114, v39
  v_mfma_f32_16x16x32_bf16 v[28:31], v[20:23], a[44:47], v[28:31]
  v_perm_b32 v20, v122, v122, v36
  v_perm_b32 v21, v122, v122, v37
  v_perm_b32 v22, v122, v122, v38
  v_perm_b32 v23, v122, v122, v39
  s_waitcnt vmcnt(5)
  v_mfma_f32_16x16x32_bf16 v[24:27], v[16:19], a[48:51], v[24:27]
  v_perm_b32 v16, v114, v114, v40
  v_perm_b32 v17, v114, v114, v41
  v_perm_b32 v18, v114, v114, v42
  v_perm_b32 v19, v114, v114, v43
  v_mfma_f32_16x16x32_bf16 v[28:31], v[20:23], a[48:51], v[28:31]
  v_perm_b32 v20, v122, v122, v40
  v_perm_b32 v21, v122, v122, v41
  v_perm_b32 v22, v122, v122, v42
  v_perm_b32 v23, v122, v122, v43
  s_waitcnt vmcnt(4)
  v_mfma_f32_16x16x32_bf16 v[24:27], v[16:19], a[52:55], v[24:27]
  v_perm_b32 v16, v115, v115, v36
  v_perm_b32 v17, v115, v115, v37
  v_perm_b32 v18, v115, v115, v38
  v_perm_b32 v19, v115, v115, v39
  v_mfma_f32_16x16x32_bf16 v[28:31], v[20:23], a[52:55], v[28:31]
  v_perm_b32 v20, v123, v123, v36
  v_perm_b32 v21, v123, v123, v37
  v_perm_b32 v22, v123, v123, v38
  v_perm_b32 v23, v123, v123, v39
  s_waitcnt vmcnt(3)
  v_mfma_f32_16x16x32_bf16 v[24:27], v[16:19], a[56:59], v[24:27]
  v_perm_b32 v16, v115, v115, v40
  v_perm_b32 v17, v115, v115, v41
  v_perm_b32 v18, v115, v115, v42
  v_perm_b32 v19, v115, v115, v43
  v_mfma_f32_16x16x32_bf16 v[28:31], v[20:23], a[56:59], v[28:31]
  v_perm_b32 v20, v123, v123, v40
  v_perm_b32 v21, v123, v123, v41
  v_perm_b32 v22, v123, v123, v42
  v_perm_b32 v23, v123, v123, v43
  s_waitcnt vmcnt(2)
  v_mfma_f32_16x16x32_bf16 v[24:27], v[16:19], a[60:63], v[24:27]
  s_nop 0
  v_mfma_f32_16x16x32_bf16 v[28:31], v[20:23], a[60:63], v[28:31]
  s_waitcnt vmcnt(0)
  v_add_u32 v124, 37, v124
  v_add_u32 v125, 39, v125
  v_add_u32 v126, 41, v126
  v_add_u32 v127, 43, v127
  v_and_b32 v124, 0x3ff, v124
  v_and_b32 v125, 0x3ff, v125
  v_and_b32 v126, 0x3ff, v126
  v_and_b32 v127, 0x3ff, v127
  v_permlane32_swap_b32 v24, v28
  v_permlane32_swap_b32 v25, v29
  v_permlane32_swap_b32 v26, v30
  v_permlane32_swap_b32 v27, v31
  v_add_f32_dpp v24, v28, v24 row_ror:8 row_mask:0xf bank_mask:0xf
  v_add_f32_dpp v25, v29, v25 row_ror:8 row_mask:0xf bank_mask:0xf
  v_add_f32_dpp v26, v30, v26 row_ror:8 row_mask:0xf bank_mask:0xf
  v_add_f32_dpp v27, v31, v27 row_ror:8 row_mask:0xf bank_mask:0xf
  v_add_u32 v24, 0x200, v24
  v_add_u32 v25, 0x200, v25
  v_add_u32 v26, 0x200, v26
  v_add_u32 v27, 0x200, v27
  v_and_or_b32 v24, v24, s90, v124
  v_and_or_b32 v25, v25, s90, v125
  v_and_or_b32 v26, v26, s90, v126
  v_and_or_b32 v27, v27, s90, v127
  s_mov_b32 exec_lo, 0x00ff00ff
  s_mov_b32 exec_hi, 0x00ff00ff
  buffer_store_dwordx4 v[24:27], v87, s[52:55], s12 offen sc1
  s_mov_b64 exec, -1
  s_cmp_lg_u32 s10, 0
  s_cbranch_scc1 L_qx_skip
  v_lshlrev_b32 v85, 1, v76
  v_and_b32 v85, 4, v85
  ds_write_b32 v85, v64 offset:8608
  s_waitcnt vmcnt(0)
  s_call_b64 s[60:61], L_qg
L_qx_skip:
  s_lshl_b32 s4, s74, 17
  s_and_b32 s90, s2, 15
  s_lshl_b32 s90, s90, 7
  s_add_u32 s4, s4, s90
  s_add_u32 s4, s4, 524288
  s_and_b32 s85, s2, 48
  s_lshl_b32 s5, s74, 12
  s_add_u32 s5, s5, 1048576
  s_lshl_b32 s8, s76, 11
  s_lshl_b32 s9, s77, 11
  s_add_u32 s9, s9, 524288
  s_mov_b32 s6, 0xfffff000
  s_waitcnt lgkmcnt(0)
  s_barrier
  buffer_load_dwordx4 v[92:95], v69, s[48:51], s93 offen
  buffer_load_dwordx4 v[96:99], v69, s[44:47], 0 offen
  buffer_load_dwordx4 v[72:75], v6, s[52:55], s5 offen sc1
  s_cmp_lg_u32 s10, 2
  s_cbranch_scc1 L_qb_skip
  s_call_b64 s[60:61], L_qg
L_qb_skip:
  v_bfe_u32 v84, v0, 3, 5
  v_and_b32 v70, 0x70, v69
  v_lshl_add_u32 v70, v84, 12, v70
  v_and_b32 v62, 3, v0
  v_lshlrev_b32 v62, 3, v62
  v_bfe_u32 v61, v11, 4, 2
  v_lshlrev_b32 v61, 3, v61
  v_mov_b32 v65, 0
  v_mov_b32 v66, 0
  v_mov_b32 v67, 0
  v_mov_b32 v68, 0
  s_add_u32 s44, s28, s83
  s_addc_u32 s45, s29, 0
  s_mov_b32 s46, 262144
  v_mov_b32 v5, v1
  s_mov_b32 s82, 4096
  s_mov_b32 s81, 0
  s_lshr_b32 s90, s2, 5
  s_lshl3_add_u32 s90, s78, s90
  s_lshl_b32 s81, s90, 12
  s_call_b64 s[60:61], L_iss0
  v_add_u32 v72, 37, v72
  v_add_u32 v73, 39, v73
  v_add_u32 v74, 41, v74
  v_add_u32 v75, 43, v75
  v_and_b32 v72, 15, v72
  v_and_b32 v73, 4095, v73
  v_and_b32 v74, 4095, v74
  v_and_b32 v75, 4095, v75
  v_mov_b32 v69, 0
  v_lshlrev_b32 v85, 16, v92
  v_lshlrev_b32 v86, 16, v96
  v_fmac_f32 v69, v85, v86
  v_and_b32 v85, 0xffff0000, v92
  v_and_b32 v86, 0xffff0000, v96
  v_fmac_f32 v69, v85, v86
  v_lshlrev_b32 v85, 16, v93
  v_lshlrev_b32 v86, 16, v97
  v_fmac_f32 v69, v85, v86
  v_and_b32 v85, 0xffff0000, v93
  v_and_b32 v86, 0xffff0000, v97
  v_fmac_f32 v69, v85, v86
  v_lshlrev_b32 v85, 16, v94
  v_lshlrev_b32 v86, 16, v98
  v_fmac_f32 v69, v85, v86
  v_and_b32 v85, 0xffff0000, v94
  v_and_b32 v86, 0xffff0000, v98
  v_fmac_f32 v69, v85, v86
  v_lshlrev_b32 v85, 16, v95
  v_lshlrev_b32 v86, 16, v99
  v_fmac_f32 v69, v85, v86
  v_and_b32 v85, 0xffff0000, v95
  v_and_b32 v86, 0xffff0000, v99
  v_fmac_f32 v69, v85, v86
  s_nop 1
  v_add_f32_dpp v69, v69, v69 row_ror:8 row_mask:0xf bank_mask:0xf
  s_nop 1
  v_add_f32_dpp v69, v69, v69 row_ror:4 row_mask:0xf bank_mask:0xf
  s_nop 1
  v_add_f32_dpp v69, v69, v69 row_ror:2 row_mask:0xf bank_mask:0xf
  s_nop 1
  v_add_f32_dpp v69, v69, v69 row_ror:1 row_mask:0xf bank_mask:0xf
  s_nop 0
  v_readlane_b32 s91, v69, 0
  v_readlane_b32 s92, v69, 16
  v_readlane_b32 s93, v69, 32
  v_readlane_b32 s94, v69, 48
  v_mov_b32 v69, s91
  v_add_f32 v69, s92, v69
  v_add_f32 v69, s93, v69
  v_add_f32 v69, s94, v69
  v_mul_f32 v69, 0xbfb8aa3b, v69
  v_exp_f32 v69, v69
  s_nop 0
  v_add_f32 v69, 1.0, v69
  v_rcp_f32 v69, v69
  s_call_b64 s[60:61], L_iss1
  s_call_b64 s[60:61], L_subbar
  s_call_b64 s[60:61], L_finq
  v_mov_b32 v24, 0
  v_mov_b32 v25, 0
  v_mov_b32 v26, 0
  v_mov_b32 v27, 0
  s_call_b64 s[60:61], L_qk0
  s_call_b64 s[60:61], L_iss0
  s_call_b64 s[60:61], L_qk1
  s_call_b64 s[60:61], L_iss1
  s_call_b64 s[60:61], L_qk0
  s_add_u32 s44, s30, s83
  s_addc_u32 s45, s31, 0
  s_mov_b32 s46, 262144
  v_mov_b32 v5, v2
  s_mov_b32 s82, 4096
  s_mov_b32 s81, 0
  s_lshr_b32 s90, s2, 5
  s_lshl3_add_u32 s90, s78, s90
  s_lshl_b32 s81, s90, 12
  s_call_b64 s[60:61], L_iss0
  s_call_b64 s[60:61], L_qk1
  s_call_b64 s[60:61], L_iss1
  v_max3_f32 v76, v52, v53, v54
  v_max_f32 v76, v76, v55
  s_nop 1
  v_max_f32_dpp v76, v76, v76 row_ror:8 row_mask:0xf bank_mask:0xf
  s_nop 1
  v_max_f32_dpp v76, v76, v76 row_ror:4 row_mask:0xf bank_mask:0xf
  s_nop 1
  v_max_f32_dpp v76, v76, v76 row_ror:2 row_mask:0xf bank_mask:0xf
  s_nop 1
  v_max_f32_dpp v76, v76, v76 row_ror:1 row_mask:0xf bank_mask:0xf
  s_nop 0
  v_readlane_b32 s91, v76, 0
  v_readlane_b32 s92, v76, 16
  v_readlane_b32 s93, v76, 32
  v_readlane_b32 s94, v76, 48
  v_max_f32 v76, s91, v76
  v_max_f32 v76, s92, v76
  v_max_f32 v76, s93, v76
  v_max_f32 v76, s94, v76
  v_mul_f32 v59, s62, v76
  v_fma_f32 v52, v52, s62, -v59
  v_fma_f32 v53, v53, s62, -v59
  v_fma_f32 v54, v54, s62, -v59
  v_fma_f32 v55, v55, s62, -v59
  v_exp_f32 v52, v52
  v_exp_f32 v53, v53
  v_exp_f32 v54, v54
  v_exp_f32 v55, v55
  s_nop 0
  v_add_f32 v60, v52, v53
  v_add_f32 v60, v60, v54
  v_add_f32 v60, v60, v55
  v_cvt_pk_bf16_f32 v52, v52, v52
  v_cvt_pk_bf16_f32 v53, v53, v53
  v_cvt_pk_bf16_f32 v54, v54, v54
  v_cvt_pk_bf16_f32 v55, v55, v55
  s_nop 1
  v_add_f32_dpp v60, v60, v60 row_ror:8 row_mask:0xf bank_mask:0xf
  s_nop 1
  v_add_f32_dpp v60, v60, v60 row_ror:4 row_mask:0xf bank_mask:0xf
  s_nop 1
  v_add_f32_dpp v60, v60, v60 row_ror:2 row_mask:0xf bank_mask:0xf
  s_nop 1
  v_add_f32_dpp v60, v60, v60 row_ror:1 row_mask:0xf bank_mask:0xf
  ds_write_b32 v10, v59 offset:8448
  ds_write_b32 v10, v60 offset:8512
  s_call_b64 s[60:61], L_pv0
  s_call_b64 s[60:61], L_iss0
  s_call_b64 s[60:61], L_pv1
  s_call_b64 s[60:61], L_iss1
  s_call_b64 s[60:61], L_pv0
  s_lshl_b32 s90, s73, 17
  s_add_u32 s44, s34, s90
  s_addc_u32 s45, s35, 0
  s_mov_b32 s46, 131072
  v_mov_b32 v5, v4
  s_mov_b32 s82, 4096
  s_mov_b32 s81, 0
  s_call_b64 s[60:61], L_iss2
  s_call_b64 s[60:61], L_pv1
  s_call_b64 s[60:61], L_iss3
  s_nop 6
  ds_write_b128 v7, v[24:27]
  s_call_b64 s[60:61], L_subbar
  v_mov_b32 v106, 8448
  ds_read_b32 v64, v6 offset:8608
  ds_read2_b32 v[76:77], v106 offset0:0 offset1:4
  ds_read2_b32 v[78:79], v106 offset0:8 offset1:12
  ds_read2st64_b32 v[80:81], v9 offset0:0 offset1:1
  ds_read2st64_b32 v[82:83], v9 offset0:2 offset1:3
  ds_read2st64_b32 v[84:85], v9 offset0:4 offset1:5
  ds_read2st64_b32 v[86:87], v9 offset0:6 offset1:7
  ds_read_b128 v[88:91], v106 offset:64
  ds_read_b128 v[92:95], v106 offset:80
  ds_read_b128 v[96:99], v106 offset:96
  ds_read_b128 v[100:103], v106 offset:112
  v_mov_b32 v24, 0
  v_mov_b32 v25, 0
  v_mov_b32 v26, 0
  v_mov_b32 v27, 0
  v_sub_f32 v107, 1.0, v69
  s_waitcnt lgkmcnt(8)
  v_readfirstlane_b32 s7, v64
  v_max3_f32 v104, v76, v77, v78
  v_max_f32 v104, v104, v79
  v_sub_f32 v76, v76, v104
  v_sub_f32 v77, v77, v104
  v_sub_f32 v78, v78, v104
  v_sub_f32 v79, v79, v104
  v_exp_f32 v76, v76
  v_exp_f32 v77, v77
  v_exp_f32 v78, v78
  v_exp_f32 v79, v79
  s_waitcnt lgkmcnt(4)
  v_mul_f32 v80, v76, v80
  v_mul_f32 v81, v76, v81
  v_fmac_f32 v80, v77, v82
  v_fmac_f32 v81, v77, v83
  v_fmac_f32 v80, v78, v84
  v_fmac_f32 v81, v78, v85
  v_fmac_f32 v80, v79, v86
  v_fmac_f32 v81, v79, v87
  s_waitcnt lgkmcnt(0)
  v_add_f32 v88, v88, v89
  v_add_f32 v90, v90, v91
  v_add_f32 v92, v92, v93
  v_add_f32 v94, v94, v95
  v_add_f32 v96, v96, v97
  v_add_f32 v98, v98, v99
  v_add_f32 v100, v100, v101
  v_add_f32 v102, v102, v103
  v_add_f32 v88, v88, v90
  v_add_f32 v92, v92, v94
  v_add_f32 v96, v96, v98
  v_add_f32 v100, v100, v102
  v_mul_f32 v105, v76, v88
  v_fmac_f32 v105, v77, v92
  v_fmac_f32 v105, v78, v96
  v_fmac_f32 v105, v79, v100
  v_rcp_f32 v76, v105
  v_log_f32 v105, v105
  s_nop 0
  v_add_f32 v104, v104, v105
  v_bfe_u32 v104, v104, v61, 8
  v_lshl_or_b32 v63, v104, 4, v72
  v_mul_f32 v107, v76, v107
  v_mul_f32 v80, v107, v80
  v_mul_f32 v81, v107, v81
  v_cvt_pk_bf16_f32 v52, v80, v80
  v_cvt_pk_bf16_f32 v53, v81, v81
  s_nop 0
  s_call_b64 s[60:61], L_pv0
  s_lshl_b32 s90, s72, 17
  s_add_u32 s44, s24, s90
  s_addc_u32 s45, s25, 0
  s_mov_b32 s46, 131072
  v_and_b32 v5, 0x3ff, v4
  v_lshrrev_b32 v4, 10, v4
  v_lshl_add_u32 v5, v4, 15, v5
  s_mov_b32 s82, 1024
  s_mov_b32 s81, 0
  s_call_b64 s[60:61], L_iss2
  s_call_b64 s[60:61], L_pv1
  s_nop 6
  v_add_u32 v24, 0x800, v24
  v_add_u32 v25, 0x800, v25
  v_add_u32 v26, 0x800, v26
  v_add_u32 v27, 0x800, v27
  v_and_or_b32 v24, v24, s6, v63
  v_and_or_b32 v25, v25, s6, v73
  v_and_or_b32 v26, v26, s6, v74
  v_and_or_b32 v27, v27, s6, v75
  s_mov_b32 exec_hi, 0
  buffer_store_dwordx4 v[24:27], v11, s[52:55], s9 offen sc1
  s_mov_b32 exec_hi, -1
  s_call_b64 s[60:61], L_iss3
  s_mov_b32 s90, 0x05040100
  s_mov_b32 s91, 0x07060302
  v_accvgpr_read_b32 v76, a0
  v_accvgpr_read_b32 v77, a1
  v_accvgpr_read_b32 v78, a2
  v_accvgpr_read_b32 v79, a3
  v_accvgpr_read_b32 v80, a4
  v_accvgpr_read_b32 v81, a5
  v_accvgpr_read_b32 v82, a6
  v_accvgpr_read_b32 v83, a7
  v_accvgpr_read_b32 v84, a8
  v_accvgpr_read_b32 v85, a9
  v_accvgpr_read_b32 v86, a10
  v_accvgpr_read_b32 v87, a11
  v_accvgpr_read_b32 v88, a12
  v_accvgpr_read_b32 v89, a13
  v_accvgpr_read_b32 v90, a14
  v_accvgpr_read_b32 v91, a15
  v_accvgpr_read_b32 v92, a16
  v_accvgpr_read_b32 v93, a17
  v_accvgpr_read_b32 v94, a18
  v_accvgpr_read_b32 v95, a19
  v_accvgpr_read_b32 v96, a20
  v_accvgpr_read_b32 v97, a21
  v_accvgpr_read_b32 v98, a22
  v_accvgpr_read_b32 v99, a23
  v_accvgpr_read_b32 v100, a24
  v_accvgpr_read_b32 v101, a25
  v_accvgpr_read_b32 v102, a26
  v_accvgpr_read_b32 v103, a27
  v_accvgpr_read_b32 v104, a28
  v_accvgpr_read_b32 v105, a29
  v_accvgpr_read_b32 v106, a30
  v_accvgpr_read_b32 v107, a31
  v_perm_b32 v28, v80, v76, s90
  v_perm_b32 v29, v88, v84, s90
  v_perm_b32 v30, v96, v92, s90
  v_perm_b32 v31, v104, v100, s90
  v_accvgpr_write_b32 a0, v28
  v_accvgpr_write_b32 a1, v29
  v_accvgpr_write_b32 a2, v30
  v_accvgpr_write_b32 a3, v31
  v_perm_b32 v28, v80, v76, s91
  v_perm_b32 v29, v88, v84, s91
  v_perm_b32 v30, v96, v92, s91
  v_perm_b32 v31, v104, v100, s91
  v_accvgpr_write_b32 a4, v28
  v_accvgpr_write_b32 a5, v29
  v_accvgpr_write_b32 a6, v30
  v_accvgpr_write_b32 a7, v31
  v_perm_b32 v28, v81, v77, s90
  v_perm_b32 v29, v89, v85, s90
  v_perm_b32 v30, v97, v93, s90
  v_perm_b32 v31, v105, v101, s90
  v_accvgpr_write_b32 a8, v28
  v_accvgpr_write_b32 a9, v29
  v_accvgpr_write_b32 a10, v30
  v_accvgpr_write_b32 a11, v31
  v_perm_b32 v28, v81, v77, s91
  v_perm_b32 v29, v89, v85, s91
  v_perm_b32 v30, v97, v93, s91
  v_perm_b32 v31, v105, v101, s91
  v_accvgpr_write_b32 a12, v28
  v_accvgpr_write_b32 a13, v29
  v_accvgpr_write_b32 a14, v30
  v_accvgpr_write_b32 a15, v31
  v_perm_b32 v28, v82, v78, s90
  v_perm_b32 v29, v90, v86, s90
  v_perm_b32 v30, v98, v94, s90
  v_perm_b32 v31, v106, v102, s90
  v_accvgpr_write_b32 a16, v28
  v_accvgpr_write_b32 a17, v29
  v_accvgpr_write_b32 a18, v30
  v_accvgpr_write_b32 a19, v31
  v_perm_b32 v28, v82, v78, s91
  v_perm_b32 v29, v90, v86, s91
  v_perm_b32 v30, v98, v94, s91
  v_perm_b32 v31, v106, v102, s91
  v_accvgpr_write_b32 a20, v28
  v_accvgpr_write_b32 a21, v29
  v_accvgpr_write_b32 a22, v30
  v_accvgpr_write_b32 a23, v31
  v_perm_b32 v28, v83, v79, s90
  v_perm_b32 v29, v91, v87, s90
  v_perm_b32 v30, v99, v95, s90
  v_perm_b32 v31, v107, v103, s90
  v_accvgpr_write_b32 a24, v28
  v_accvgpr_write_b32 a25, v29
  v_accvgpr_write_b32 a26, v30
  v_accvgpr_write_b32 a27, v31
  v_perm_b32 v28, v83, v79, s91
  v_perm_b32 v29, v91, v87, s91
  v_perm_b32 v30, v99, v95, s91
  v_perm_b32 v31, v107, v103, s91
  v_accvgpr_write_b32 a28, v28
  v_accvgpr_write_b32 a29, v29
  v_accvgpr_write_b32 a30, v30
  v_accvgpr_write_b32 a31, v31
  v_accvgpr_read_b32 v76, a32
  v_accvgpr_read_b32 v77, a33
  v_accvgpr_read_b32 v78, a34
  v_accvgpr_read_b32 v79, a35
  v_accvgpr_read_b32 v80, a36
  v_accvgpr_read_b32 v81, a37
  v_accvgpr_read_b32 v82, a38
  v_accvgpr_read_b32 v83, a39
  v_accvgpr_read_b32 v84, a40
  v_accvgpr_read_b32 v85, a41
  v_accvgpr_read_b32 v86, a42
  v_accvgpr_read_b32 v87, a43
  v_accvgpr_read_b32 v88, a44
  v_accvgpr_read_b32 v89, a45
  v_accvgpr_read_b32 v90, a46
  v_accvgpr_read_b32 v91, a47
  v_accvgpr_read_b32 v92, a48
  v_accvgpr_read_b32 v93, a49
  v_accvgpr_read_b32 v94, a50
  v_accvgpr_read_b32 v95, a51
  v_accvgpr_read_b32 v96, a52
  v_accvgpr_read_b32 v97, a53
  v_accvgpr_read_b32 v98, a54
  v_accvgpr_read_b32 v99, a55
  v_accvgpr_read_b32 v100, a56
  v_accvgpr_read_b32 v101, a57
  v_accvgpr_read_b32 v102, a58
  v_accvgpr_read_b32 v103, a59
  v_accvgpr_read_b32 v104, a60
  v_accvgpr_read_b32 v105, a61
  v_accvgpr_read_b32 v106, a62
  v_accvgpr_read_b32 v107, a63
  v_perm_b32 v28, v80, v76, s90
  v_perm_b32 v29, v88, v84, s90
  v_perm_b32 v30, v96, v92, s90
  v_perm_b32 v31, v104, v100, s90
  v_accvgpr_write_b32 a32, v28
  v_accvgpr_write_b32 a33, v29
  v_accvgpr_write_b32 a34, v30
  v_accvgpr_write_b32 a35, v31
  v_perm_b32 v28, v80, v76, s91
  v_perm_b32 v29, v88, v84, s91
  v_perm_b32 v30, v96, v92, s91
  v_perm_b32 v31, v104, v100, s91
  v_accvgpr_write_b32 a36, v28
  v_accvgpr_write_b32 a37, v29
  v_accvgpr_write_b32 a38, v30
  v_accvgpr_write_b32 a39, v31
  v_perm_b32 v28, v81, v77, s90
  v_perm_b32 v29, v89, v85, s90
  v_perm_b32 v30, v97, v93, s90
  v_perm_b32 v31, v105, v101, s90
  v_accvgpr_write_b32 a40, v28
  v_accvgpr_write_b32 a41, v29
  v_accvgpr_write_b32 a42, v30
  v_accvgpr_write_b32 a43, v31
  v_perm_b32 v28, v81, v77, s91
  v_perm_b32 v29, v89, v85, s91
  v_perm_b32 v30, v97, v93, s91
  v_perm_b32 v31, v105, v101, s91
  v_accvgpr_write_b32 a44, v28
  v_accvgpr_write_b32 a45, v29
  v_accvgpr_write_b32 a46, v30
  v_accvgpr_write_b32 a47, v31
  v_perm_b32 v28, v82, v78, s90
  v_perm_b32 v29, v90, v86, s90
  v_perm_b32 v30, v98, v94, s90
  v_perm_b32 v31, v106, v102, s90
  v_accvgpr_write_b32 a48, v28
  v_accvgpr_write_b32 a49, v29
  v_accvgpr_write_b32 a50, v30
  v_accvgpr_write_b32 a51, v31
  v_perm_b32 v28, v82, v78, s91
  v_perm_b32 v29, v90, v86, s91
  v_perm_b32 v30, v98, v94, s91
  v_perm_b32 v31, v106, v102, s91
  v_accvgpr_write_b32 a52, v28
  v_accvgpr_write_b32 a53, v29
  v_accvgpr_write_b32 a54, v30
  v_accvgpr_write_b32 a55, v31
  v_perm_b32 v28, v83, v79, s90
  v_perm_b32 v29, v91, v87, s90
  v_perm_b32 v30, v99, v95, s90
  v_perm_b32 v31, v107, v103, s90
  v_accvgpr_write_b32 a56, v28
  v_accvgpr_write_b32 a57, v29
  v_accvgpr_write_b32 a58, v30
  v_accvgpr_write_b32 a59, v31
  v_perm_b32 v28, v83, v79, s91
  v_perm_b32 v29, v91, v87, s91
  v_perm_b32 v30, v99, v95, s91
  v_perm_b32 v31, v107, v103, s91
  v_accvgpr_write_b32 a60, v28
  v_accvgpr_write_b32 a61, v29
  v_accvgpr_write_b32 a62, v30
  v_accvgpr_write_b32 a63, v31
  v_accvgpr_read_b32 v76, a64
  v_accvgpr_read_b32 v77, a65
  v_accvgpr_read_b32 v78, a66
  v_accvgpr_read_b32 v79, a67
  v_accvgpr_read_b32 v80, a68
  v_accvgpr_read_b32 v81, a69
  v_accvgpr_read_b32 v82, a70
  v_accvgpr_read_b32 v83, a71
  v_accvgpr_read_b32 v84, a72
  v_accvgpr_read_b32 v85, a73
  v_accvgpr_read_b32 v86, a74
  v_accvgpr_read_b32 v87, a75
  v_accvgpr_read_b32 v88, a76
  v_accvgpr_read_b32 v89, a77
  v_accvgpr_read_b32 v90, a78
  v_accvgpr_read_b32 v91, a79
  v_accvgpr_read_b32 v92, a80
  v_accvgpr_read_b32 v93, a81
  v_accvgpr_read_b32 v94, a82
  v_accvgpr_read_b32 v95, a83
  v_accvgpr_read_b32 v96, a84
  v_accvgpr_read_b32 v97, a85
  v_accvgpr_read_b32 v98, a86
  v_accvgpr_read_b32 v99, a87
  v_accvgpr_read_b32 v100, a88
  v_accvgpr_read_b32 v101, a89
  v_accvgpr_read_b32 v102, a90
  v_accvgpr_read_b32 v103, a91
  v_accvgpr_read_b32 v104, a92
  v_accvgpr_read_b32 v105, a93
  v_accvgpr_read_b32 v106, a94
  v_accvgpr_read_b32 v107, a95
  v_perm_b32 v28, v80, v76, s90
  v_perm_b32 v29, v88, v84, s90
  v_perm_b32 v30, v96, v92, s90
  v_perm_b32 v31, v104, v100, s90
  v_accvgpr_write_b32 a64, v28
  v_accvgpr_write_b32 a65, v29
  v_accvgpr_write_b32 a66, v30
  v_accvgpr_write_b32 a67, v31
  v_perm_b32 v28, v80, v76, s91
  v_perm_b32 v29, v88, v84, s91
  v_perm_b32 v30, v96, v92, s91
  v_perm_b32 v31, v104, v100, s91
  v_accvgpr_write_b32 a68, v28
  v_accvgpr_write_b32 a69, v29
  v_accvgpr_write_b32 a70, v30
  v_accvgpr_write_b32 a71, v31
  v_perm_b32 v28, v81, v77, s90
  v_perm_b32 v29, v89, v85, s90
  v_perm_b32 v30, v97, v93, s90
  v_perm_b32 v31, v105, v101, s90
  v_accvgpr_write_b32 a72, v28
  v_accvgpr_write_b32 a73, v29
  v_accvgpr_write_b32 a74, v30
  v_accvgpr_write_b32 a75, v31
  v_perm_b32 v28, v81, v77, s91
  v_perm_b32 v29, v89, v85, s91
  v_perm_b32 v30, v97, v93, s91
  v_perm_b32 v31, v105, v101, s91
  v_accvgpr_write_b32 a76, v28
  v_accvgpr_write_b32 a77, v29
  v_accvgpr_write_b32 a78, v30
  v_accvgpr_write_b32 a79, v31
  v_perm_b32 v28, v82, v78, s90
  v_perm_b32 v29, v90, v86, s90
  v_perm_b32 v30, v98, v94, s90
  v_perm_b32 v31, v106, v102, s90
  v_accvgpr_write_b32 a80, v28
  v_accvgpr_write_b32 a81, v29
  v_accvgpr_write_b32 a82, v30
  v_accvgpr_write_b32 a83, v31
  v_perm_b32 v28, v82, v78, s91
  v_perm_b32 v29, v90, v86, s91
  v_perm_b32 v30, v98, v94, s91
  v_perm_b32 v31, v106, v102, s91
  v_accvgpr_write_b32 a84, v28
  v_accvgpr_write_b32 a85, v29
  v_accvgpr_write_b32 a86, v30
  v_accvgpr_write_b32 a87, v31
  v_perm_b32 v28, v83, v79, s90
  v_perm_b32 v29, v91, v87, s90
  v_perm_b32 v30, v99, v95, s90
  v_perm_b32 v31, v107, v103, s90
  v_accvgpr_write_b32 a88, v28
  v_accvgpr_write_b32 a89, v29
  v_accvgpr_write_b32 a90, v30
  v_accvgpr_write_b32 a91, v31
  v_perm_b32 v28, v83, v79, s91
  v_perm_b32 v29, v91, v87, s91
  v_perm_b32 v30, v99, v95, s91
  v_perm_b32 v31, v107, v103, s91
  v_accvgpr_write_b32 a92, v28
  v_accvgpr_write_b32 a93, v29
  v_accvgpr_write_b32 a94, v30
  v_accvgpr_write_b32 a95, v31
  s_waitcnt vmcnt(0)
  v_accvgpr_read_b32 v76, a96
  v_accvgpr_read_b32 v77, a97
  v_accvgpr_read_b32 v78, a98
  v_accvgpr_read_b32 v79, a99
  v_accvgpr_read_b32 v80, a100
  v_accvgpr_read_b32 v81, a101
  v_accvgpr_read_b32 v82, a102
  v_accvgpr_read_b32 v83, a103
  v_accvgpr_read_b32 v84, a104
  v_accvgpr_read_b32 v85, a105
  v_accvgpr_read_b32 v86, a106
  v_accvgpr_read_b32 v87, a107
  v_accvgpr_read_b32 v88, a108
  v_accvgpr_read_b32 v89, a109
  v_accvgpr_read_b32 v90, a110
  v_accvgpr_read_b32 v91, a111
  v_accvgpr_read_b32 v92, a112
  v_accvgpr_read_b32 v93, a113
  v_accvgpr_read_b32 v94, a114
  v_accvgpr_read_b32 v95, a115
  v_accvgpr_read_b32 v96, a116
  v_accvgpr_read_b32 v97, a117
  v_accvgpr_read_b32 v98, a118
  v_accvgpr_read_b32 v99, a119
  v_accvgpr_read_b32 v100, a120
  v_accvgpr_read_b32 v101, a121
  v_accvgpr_read_b32 v102, a122
  v_accvgpr_read_b32 v103, a123
  v_accvgpr_read_b32 v104, a124
  v_accvgpr_read_b32 v105, a125
  v_accvgpr_read_b32 v106, a126
  v_accvgpr_read_b32 v107, a127
  v_perm_b32 v28, v80, v76, s90
  v_perm_b32 v29, v88, v84, s90
  v_perm_b32 v30, v96, v92, s90
  v_perm_b32 v31, v104, v100, s90
  v_accvgpr_write_b32 a96, v28
  v_accvgpr_write_b32 a97, v29
  v_accvgpr_write_b32 a98, v30
  v_accvgpr_write_b32 a99, v31
  v_perm_b32 v28, v80, v76, s91
  v_perm_b32 v29, v88, v84, s91
  v_perm_b32 v30, v96, v92, s91
  v_perm_b32 v31, v104, v100, s91
  v_accvgpr_write_b32 a100, v28
  v_accvgpr_write_b32 a101, v29
  v_accvgpr_write_b32 a102, v30
  v_accvgpr_write_b32 a103, v31
  v_perm_b32 v28, v81, v77, s90
  v_perm_b32 v29, v89, v85, s90
  v_perm_b32 v30, v97, v93, s90
  v_perm_b32 v31, v105, v101, s90
  v_accvgpr_write_b32 a104, v28
  v_accvgpr_write_b32 a105, v29
  v_accvgpr_write_b32 a106, v30
  v_accvgpr_write_b32 a107, v31
  v_perm_b32 v28, v81, v77, s91
  v_perm_b32 v29, v89, v85, s91
  v_perm_b32 v30, v97, v93, s91
  v_perm_b32 v31, v105, v101, s91
  v_accvgpr_write_b32 a108, v28
  v_accvgpr_write_b32 a109, v29
  v_accvgpr_write_b32 a110, v30
  v_accvgpr_write_b32 a111, v31
  v_perm_b32 v28, v82, v78, s90
  v_perm_b32 v29, v90, v86, s90
  v_perm_b32 v30, v98, v94, s90
  v_perm_b32 v31, v106, v102, s90
  v_accvgpr_write_b32 a112, v28
  v_accvgpr_write_b32 a113, v29
  v_accvgpr_write_b32 a114, v30
  v_accvgpr_write_b32 a115, v31
  v_perm_b32 v28, v82, v78, s91
  v_perm_b32 v29, v90, v86, s91
  v_perm_b32 v30, v98, v94, s91
  v_perm_b32 v31, v106, v102, s91
  v_accvgpr_write_b32 a116, v28
  v_accvgpr_write_b32 a117, v29
  v_accvgpr_write_b32 a118, v30
  v_accvgpr_write_b32 a119, v31
  v_perm_b32 v28, v83, v79, s90
  v_perm_b32 v29, v91, v87, s90
  v_perm_b32 v30, v99, v95, s90
  v_perm_b32 v31, v107, v103, s90
  v_accvgpr_write_b32 a120, v28
  v_accvgpr_write_b32 a121, v29
  v_accvgpr_write_b32 a122, v30
  v_accvgpr_write_b32 a123, v31
  v_perm_b32 v28, v83, v79, s91
  v_perm_b32 v29, v91, v87, s91
  v_perm_b32 v30, v99, v95, s91
  v_perm_b32 v31, v107, v103, s91
  v_accvgpr_write_b32 a124, v28
  v_accvgpr_write_b32 a125, v29
  v_accvgpr_write_b32 a126, v30
  v_accvgpr_write_b32 a127, v31
  s_waitcnt vmcnt(0)
  v_and_b32 v76, 3, v0
  v_lshlrev_b32 v76, 8, v76
  v_add_u32 v76, 6144, v76
  v_bfe_u32 v77, v0, 2, 2
  v_mov_b32 v78, 7168
  v_bfe_u32 v79, v0, 4, 2
  v_cmp_eq_u32 vcc, 0, v77
  s_nop 1
  v_cndmask_b32 v16, v78, v76, vcc
  v_lshl_add_u32 v16, v79, 6, v16
  v_cmp_eq_u32 vcc, 1, v77
  s_nop 1
  v_cndmask_b32 v17, v78, v76, vcc
  v_lshl_add_u32 v17, v79, 6, v17
  s_lshl_b32 s90, s74, 10
  s_add_u32 s48, s38, s90
  s_addc_u32 s49, s39, 0
  s_mov_b32 s50, 1024
  s_mov_b32 s86, 1
  s_mov_b64 s[56:57], -1
  s_cmp_lg_u32 s85, 0
  s_cbranch_scc1 L_nocons0
  s_call_b64 s[60:61], L_gather
L_nocons0:
  s_mul_i32 s98, s80, 4
  s_add_u32 s98, s98, 4
  s_mov_b64 exec, 1
  s_mov_b32 s88, 0x400000
  s_branch L_ag
L_ag_sl:
  s_sub_u32 s88, s88, 1
  s_cbranch_scc1 L_ag_ret
  s_sleep 1
L_ag:
  ds_read_b64 v[76:77], v6 offset:8600
  v_mov_b32 v78, 4
  s_mov_b32 s93, 0x10000
  s_waitcnt lgkmcnt(0)
  v_readfirstlane_b32 s90, v76
  v_readfirstlane_b32 s91, v77
  s_cmp_ge_u32 s91, s93
  s_cbranch_scc1 L_ag_ret
  s_lshr_b32 s91, s90, 16
  s_and_b32 s90, s90, 0xffff
  s_add_u32 s90, s90, s91
  s_cmp_le_i32 s90, s98
  s_cbranch_scc1 L_ag_sl
  buffer_atomic_add v78, v6, s[52:55], s63 offen sc0 sc1
  s_add_u32 s98, s98, 16
  s_waitcnt vmcnt(0)
  v_readfirstlane_b32 s92, v78
  s_sub_u32 s92, s92, s7
  s_cmp_ge_u32 s92, 28
  s_cselect_b32 s93, s93, 0
  s_cmp_lt_u32 s92, 32
  s_cselect_b32 s92, 4, 0
  s_or_b32 s93, s93, s92
L_ag_ret:
  v_mov_b32 v76, s93
  ds_add_u32 v6, v76 offset:8604
  s_cmp_eq_u32 s93, 4
  s_cbranch_scc1 L_ag
  s_mov_b64 exec, -1
  s_cmp_lg_u32 s85, 0
  s_cbranch_scc1 L_nocons1
  s_cmp_lg_u32 s86, 2
  s_cbranch_scc1 L_gotb
  s_call_b64 s[60:61], L_gather
L_gotb:
  s_sub_u32 s4, s4, 524288
  s_mov_b32 s86, 0
  s_mov_b64 s[56:57], -1
  v_and_b32 v52, 7, v0
  v_bfe_u32 v53, v0, 4, 2
  v_lshl_add_u32 v52, v52, 2, v53
  v_bfe_u32 v53, v0, 6, 2
  v_lshl_add_u32 v52, v53, 5, v52
  v_lshlrev_b32 v52, 2, v52
  v_and_b32 v53, 31, v0
  v_lshlrev_b32 v54, 2, v53
  v_lshlrev_b32 v55, 1, v53
  v_add_u32 v54, 8704, v54
  s_and_b32 s87, s4, 0x7ff
  s_cselect_b32 s5, s89, s5
  s_lshr_b32 s87, s87, 1
L_nocons1:
  s_barrier
  ds_read_b128 v[76:79], v16 offset:0
  ds_read_b128 v[80:83], v17 offset:0
  ds_read_b128 v[28:31], v6 offset:8576
  ds_read_b128 v[84:87], v16 offset:16
  ds_read_b128 v[88:91], v17 offset:16
  ds_read_b128 v[108:111], v6 offset:7424
  ds_read_b128 v[112:115], v6 offset:7440
  ds_read_b128 v[116:119], v6 offset:7456
  ds_read_b128 v[120:123], v6 offset:7472
  ds_read_b128 v[92:95], v16 offset:32
  ds_read_b128 v[96:99], v17 offset:32
  ds_read_b128 v[100:103], v16 offset:48
  ds_read_b128 v[104:107], v17 offset:48
  s_waitcnt lgkmcnt(12)
  v_mfma_f32_16x16x32_bf16 v[36:39], v[76:79], a[0:3], 0
  v_mfma_f32_16x16x32_bf16 v[40:43], v[76:79], a[4:7], 0
  s_waitcnt lgkmcnt(11)
  v_mfma_f32_16x16x32_bf16 v[36:39], v[80:83], a[16:19], v[36:39]
  v_mfma_f32_16x16x32_bf16 v[40:43], v[80:83], a[20:23], v[40:43]
  s_waitcnt lgkmcnt(9)
  v_mfma_f32_16x16x32_bf16 v[36:39], v[84:87], a[32:35], v[36:39]
  v_max3_f32 v32, v28, v29, v30
  v_max_f32 v32, v32, v31
  v_mfma_f32_16x16x32_bf16 v[40:43], v[84:87], a[36:39], v[40:43]
  v_sub_f32 v28, v28, v32
  v_sub_f32 v29, v29, v32
  s_waitcnt lgkmcnt(8)
  v_mfma_f32_16x16x32_bf16 v[36:39], v[88:91], a[48:51], v[36:39]
  v_sub_f32 v30, v30, v32
  v_sub_f32 v31, v31, v32
  v_mfma_f32_16x16x32_bf16 v[40:43], v[88:91], a[52:55], v[40:43]
  v_exp_f32 v28, v28
  v_exp_f32 v29, v29
  s_waitcnt lgkmcnt(3)
  v_mfma_f32_16x16x32_bf16 v[36:39], v[92:95], a[64:67], v[36:39]
  v_exp_f32 v30, v30
  v_exp_f32 v31, v31
  v_mfma_f32_16x16x32_bf16 v[40:43], v[92:95], a[68:71], v[40:43]
  v_add_f32 v108, v108, v109
  v_add_f32 v110, v110, v111
  s_waitcnt lgkmcnt(2)
  v_mfma_f32_16x16x32_bf16 v[36:39], v[96:99], a[80:83], v[36:39]
  v_add_f32 v112, v112, v113
  v_add_f32 v114, v114, v115
  v_mfma_f32_16x16x32_bf16 v[40:43], v[96:99], a[84:87], v[40:43]
  v_add_f32 v116, v116, v117
  v_add_f32 v118, v118, v119
  s_waitcnt lgkmcnt(1)
  v_mfma_f32_16x16x32_bf16 v[36:39], v[100:103], a[96:99], v[36:39]
  v_add_f32 v120, v120, v121
  v_add_f32 v122, v122, v123
  v_mfma_f32_16x16x32_bf16 v[40:43], v[100:103], a[100:103], v[40:43]
  v_add_f32 v108, v108, v110
  v_add_f32 v112, v112, v114
  s_waitcnt lgkmcnt(0)
  v_mfma_f32_16x16x32_bf16 v[36:39], v[104:107], a[112:115], v[36:39]
  v_add_f32 v116, v116, v118
  v_add_f32 v120, v120, v122
  v_mfma_f32_16x16x32_bf16 v[40:43], v[104:107], a[116:119], v[40:43]
  v_mul_f32 v33, v28, v108
  v_fmac_f32 v33, v29, v112
  v_mfma_f32_16x16x32_bf16 v[44:47], v[76:79], a[8:11], 0
  v_fmac_f32 v33, v30, v116
  v_fmac_f32 v33, v31, v120
  v_mfma_f32_16x16x32_bf16 v[48:51], v[76:79], a[12:15], 0
  v_rcp_f32 v34, v33
  v_log_f32 v33, v33
  v_mfma_f32_16x16x32_bf16 v[44:47], v[80:83], a[24:27], v[44:47]
  v_mul_f32 v34, v69, v34
  v_add_f32 v32, v32, v33
  v_mfma_f32_16x16x32_bf16 v[48:51], v[80:83], a[28:31], v[48:51]
  v_mul_f32 v28, v34, v28
  v_mul_f32 v29, v34, v29
  v_mfma_f32_16x16x32_bf16 v[44:47], v[84:87], a[40:43], v[44:47]
  v_mul_f32 v30, v34, v30
  v_mul_f32 v31, v34, v31
  v_mfma_f32_16x16x32_bf16 v[48:51], v[84:87], a[44:47], v[48:51]
  v_bfe_u32 v32, v32, v61, 8
  v_lshl_or_b32 v63, v32, 4, v72
  v_mfma_f32_16x16x32_bf16 v[44:47], v[88:91], a[56:59], v[44:47]
  v_mfma_f32_16x16x32_bf16 v[48:51], v[88:91], a[60:63], v[48:51]
  v_mul_f32 v24, v28, v36
  v_mul_f32 v25, v28, v40
  v_mfma_f32_16x16x32_bf16 v[44:47], v[92:95], a[72:75], v[44:47]
  v_fmac_f32 v24, v29, v37
  v_fmac_f32 v25, v29, v41
  v_mfma_f32_16x16x32_bf16 v[48:51], v[92:95], a[76:79], v[48:51]
  v_fmac_f32 v24, v30, v38
  v_fmac_f32 v25, v30, v42
  v_mfma_f32_16x16x32_bf16 v[44:47], v[96:99], a[88:91], v[44:47]
  v_fmac_f32 v24, v31, v39
  v_fmac_f32 v25, v31, v43
  v_mfma_f32_16x16x32_bf16 v[48:51], v[96:99], a[92:95], v[48:51]
  v_add_u32 v24, 0x800, v24
  v_add_u32 v25, 0x800, v25
  v_mfma_f32_16x16x32_bf16 v[44:47], v[100:103], a[104:107], v[44:47]
  v_and_or_b32 v24, v24, s6, v63
  v_and_or_b32 v25, v25, s6, v73
  v_mfma_f32_16x16x32_bf16 v[48:51], v[100:103], a[108:111], v[48:51]
  v_mfma_f32_16x16x32_bf16 v[44:47], v[104:107], a[120:123], v[44:47]
  v_mfma_f32_16x16x32_bf16 v[48:51], v[104:107], a[124:127], v[48:51]
  s_mov_b32 exec_hi, 0
  s_nop 5
  v_mul_f32 v26, v28, v44
  v_mul_f32 v27, v28, v48
  v_fmac_f32 v26, v29, v45
  v_fmac_f32 v27, v29, v49
  v_fmac_f32 v26, v30, v46
  v_fmac_f32 v27, v30, v50
  v_fmac_f32 v26, v31, v47
  v_fmac_f32 v27, v31, v51
  v_add_u32 v26, 0x800, v26
  v_add_u32 v27, 0x800, v27
  v_and_or_b32 v26, v26, s6, v74
  v_and_or_b32 v27, v27, s6, v75
  buffer_store_dwordx4 v[24:27], v11, s[52:55], s8 offen sc1
  s_cmp_lg_u32 s85, 0
  s_cbranch_scc1 L_sdone
  s_call_b64 s[60:61], L_gather
  v_add_f32_dpp v65, v65, v65 row_ror:8 row_mask:0xf bank_mask:0xf
  v_add_f32_dpp v66, v66, v66 row_ror:8 row_mask:0xf bank_mask:0xf
  v_add_f32_dpp v67, v67, v67 row_ror:8 row_mask:0xf bank_mask:0xf
  v_add_f32_dpp v68, v68, v68 row_ror:8 row_mask:0xf bank_mask:0xf
  s_nop 0
  v_permlane16_swap_b32 v65, v66
  v_permlane16_swap_b32 v67, v68
  s_nop 0
  v_add_f32 v65, v65, v66
  v_add_f32 v67, v67, v68
  s_nop 1
  v_permlane32_swap_b32 v65, v67
  s_nop 1
  v_add_f32 v65, v65, v67
  ds_write_b32 v52, v65 offset:8704
  s_cmp_lg_u32 s80, 0
  s_waitcnt lgkmcnt(0)
  s_barrier
  s_cbranch_scc1 L_sdone
  ds_read2_b32 v[108:109], v54 offset0:0 offset1:32
  ds_read2_b32 v[110:111], v54 offset0:64 offset1:96
  s_mov_b32 exec_hi, 0
  s_waitcnt lgkmcnt(0)
  v_add_f32 v108, v108, v109
  v_add_f32 v110, v110, v111
  v_add_f32 v108, v108, v110
  v_cvt_pk_bf16_f32 v108, v108, v108
  buffer_store_short v108, v55, s[48:51], s87 offen
  s_mov_b64 exec, 1
  buffer_store_dwordx4 v[72:75], v6, s[52:55], s5 offen sc1
L_sdone:
  s_endpgm
L_iss0:
  s_waitcnt vmcnt(4)
  buffer_load_dwordx4 a[0:3], v5, s[44:47], s81 offen
  s_xor_b32 s81, s81, 32768
  s_waitcnt vmcnt(4)
  buffer_load_dwordx4 a[4:7], v5, s[44:47], s81 offen
  s_xor_b32 s81, s81, 98304
  s_waitcnt vmcnt(4)
  buffer_load_dwordx4 a[8:11], v5, s[44:47], s81 offen
  s_xor_b32 s81, s81, 32768
  s_waitcnt vmcnt(4)
  buffer_load_dwordx4 a[12:15], v5, s[44:47], s81 offen
  s_xor_b32 s81, s81, 229376
  s_waitcnt vmcnt(4)
  buffer_load_dwordx4 a[16:19], v5, s[44:47], s81 offen
  s_xor_b32 s81, s81, 32768
  s_waitcnt vmcnt(4)
  buffer_load_dwordx4 a[20:23], v5, s[44:47], s81 offen
  s_xor_b32 s81, s81, 98304
  s_waitcnt vmcnt(4)
  buffer_load_dwordx4 a[24:27], v5, s[44:47], s81 offen
  s_xor_b32 s81, s81, 32768
  s_waitcnt vmcnt(4)
  buffer_load_dwordx4 a[28:31], v5, s[44:47], s81 offen
  s_xor_b32 s81, s81, 233472
  s_waitcnt vmcnt(4)
  buffer_load_dwordx4 a[32:35], v5, s[44:47], s81 offen
  s_xor_b32 s81, s81, 32768
  s_waitcnt vmcnt(4)
  buffer_load_dwordx4 a[36:39], v5, s[44:47], s81 offen
  s_xor_b32 s81, s81, 98304
  s_waitcnt vmcnt(4)
  buffer_load_dwordx4 a[40:43], v5, s[44:47], s81 offen
  s_xor_b32 s81, s81, 32768
  s_waitcnt vmcnt(4)
  buffer_load_dwordx4 a[44:47], v5, s[44:47], s81 offen
  s_xor_b32 s81, s81, 229376
  s_waitcnt vmcnt(4)
  buffer_load_dwordx4 a[48:51], v5, s[44:47], s81 offen
  s_xor_b32 s81, s81, 32768
  s_waitcnt vmcnt(4)
  buffer_load_dwordx4 a[52:55], v5, s[44:47], s81 offen
  s_xor_b32 s81, s81, 98304
  s_waitcnt vmcnt(4)
  buffer_load_dwordx4 a[56:59], v5, s[44:47], s81 offen
  s_xor_b32 s81, s81, 32768
  s_waitcnt vmcnt(4)
  buffer_load_dwordx4 a[60:63], v5, s[44:47], s81 offen
  s_xor_b32 s81, s81, 241664
  s_setpc_b64 s[60:61]
L_iss1:
  s_waitcnt vmcnt(4)
  buffer_load_dwordx4 a[64:67], v5, s[44:47], s81 offen
  s_xor_b32 s81, s81, 32768
  s_waitcnt vmcnt(4)
  buffer_load_dwordx4 a[68:71], v5, s[44:47], s81 offen
  s_xor_b32 s81, s81, 98304
  s_waitcnt vmcnt(4)
  buffer_load_dwordx4 a[72:75], v5, s[44:47], s81 offen
  s_xor_b32 s81, s81, 32768
  s_waitcnt vmcnt(4)
  buffer_load_dwordx4 a[76:79], v5, s[44:47], s81 offen
  s_xor_b32 s81, s81, 229376
  s_waitcnt vmcnt(4)
  buffer_load_dwordx4 a[80:83], v5, s[44:47], s81 offen
  s_xor_b32 s81, s81, 32768
  s_waitcnt vmcnt(4)
  buffer_load_dwordx4 a[84:87], v5, s[44:47], s81 offen
  s_xor_b32 s81, s81, 98304
  s_waitcnt vmcnt(4)
  buffer_load_dwordx4 a[88:91], v5, s[44:47], s81 offen
  s_xor_b32 s81, s81, 32768
  s_waitcnt vmcnt(4)
  buffer_load_dwordx4 a[92:95], v5, s[44:47], s81 offen
  s_xor_b32 s81, s81, 233472
  s_waitcnt vmcnt(4)
  buffer_load_dwordx4 a[96:99], v5, s[44:47], s81 offen
  s_xor_b32 s81, s81, 32768
  s_waitcnt vmcnt(4)
  buffer_load_dwordx4 a[100:103], v5, s[44:47], s81 offen
  s_xor_b32 s81, s81, 98304
  s_waitcnt vmcnt(4)
  buffer_load_dwordx4 a[104:107], v5, s[44:47], s81 offen
  s_xor_b32 s81, s81, 32768
  s_waitcnt vmcnt(4)
  buffer_load_dwordx4 a[108:111], v5, s[44:47], s81 offen
  s_xor_b32 s81, s81, 229376
  s_waitcnt vmcnt(4)
  buffer_load_dwordx4 a[112:115], v5, s[44:47], s81 offen
  s_xor_b32 s81, s81, 32768
  s_waitcnt vmcnt(4)
  buffer_load_dwordx4 a[116:119], v5, s[44:47], s81 offen
  s_xor_b32 s81, s81, 98304
  s_waitcnt vmcnt(4)
  buffer_load_dwordx4 a[120:123], v5, s[44:47], s81 offen
  s_xor_b32 s81, s81, 32768
  s_waitcnt vmcnt(4)
  buffer_load_dwordx4 a[124:127], v5, s[44:47], s81 offen
  s_xor_b32 s81, s81, 258048
  s_setpc_b64 s[60:61]
L_iss2:
  s_waitcnt vmcnt(4)
  buffer_load_dwordx4 a[0:3], v5, s[44:47], s81 offen
  s_add_u32 s81, s81, s82
  s_waitcnt vmcnt(4)
  buffer_load_dwordx4 a[4:7], v5, s[44:47], s81 offen
  s_add_u32 s81, s81, s82
  s_waitcnt vmcnt(4)
  buffer_load_dwordx4 a[8:11], v5, s[44:47], s81 offen
  s_add_u32 s81, s81, s82
  s_waitcnt vmcnt(4)
  buffer_load_dwordx4 a[12:15], v5, s[44:47], s81 offen
  s_add_u32 s81, s81, s82
  s_waitcnt vmcnt(4)
  buffer_load_dwordx4 a[16:19], v5, s[44:47], s81 offen
  s_add_u32 s81, s81, s82
  s_waitcnt vmcnt(4)
  buffer_load_dwordx4 a[20:23], v5, s[44:47], s81 offen
  s_add_u32 s81, s81, s82
  s_waitcnt vmcnt(4)
  buffer_load_dwordx4 a[24:27], v5, s[44:47], s81 offen
  s_add_u32 s81, s81, s82
  s_waitcnt vmcnt(4)
  buffer_load_dwordx4 a[28:31], v5, s[44:47], s81 offen
  s_add_u32 s81, s81, s82
  s_waitcnt vmcnt(4)
  buffer_load_dwordx4 a[32:35], v5, s[44:47], s81 offen
  s_add_u32 s81, s81, s82
  s_waitcnt vmcnt(4)
  buffer_load_dwordx4 a[36:39], v5, s[44:47], s81 offen
  s_add_u32 s81, s81, s82
  s_waitcnt vmcnt(4)
  buffer_load_dwordx4 a[40:43], v5, s[44:47], s81 offen
  s_add_u32 s81, s81, s82
  s_waitcnt vmcnt(4)
  buffer_load_dwordx4 a[44:47], v5, s[44:47], s81 offen
  s_add_u32 s81, s81, s82
  s_waitcnt vmcnt(4)
  buffer_load_dwordx4 a[48:51], v5, s[44:47], s81 offen
  s_add_u32 s81, s81, s82
  s_waitcnt vmcnt(4)
  buffer_load_dwordx4 a[52:55], v5, s[44:47], s81 offen
  s_add_u32 s81, s81, s82
  s_waitcnt vmcnt(4)
  buffer_load_dwordx4 a[56:59], v5, s[44:47], s81 offen
  s_add_u32 s81, s81, s82
  s_waitcnt vmcnt(4)
  buffer_load_dwordx4 a[60:63], v5, s[44:47], s81 offen
  s_add_u32 s81, s81, s82
  s_setpc_b64 s[60:61]
L_iss3:
  s_waitcnt vmcnt(4)
  buffer_load_dwordx4 a[64:67], v5, s[44:47], s81 offen
  s_add_u32 s81, s81, s82
  s_waitcnt vmcnt(4)
  buffer_load_dwordx4 a[68:71], v5, s[44:47], s81 offen
  s_add_u32 s81, s81, s82
  s_waitcnt vmcnt(4)
  buffer_load_dwordx4 a[72:75], v5, s[44:47], s81 offen
  s_add_u32 s81, s81, s82
  s_waitcnt vmcnt(4)
  buffer_load_dwordx4 a[76:79], v5, s[44:47], s81 offen
  s_add_u32 s81, s81, s82
  s_waitcnt vmcnt(4)
  buffer_load_dwordx4 a[80:83], v5, s[44:47], s81 offen
  s_add_u32 s81, s81, s82
  s_waitcnt vmcnt(4)
  buffer_load_dwordx4 a[84:87], v5, s[44:47], s81 offen
  s_add_u32 s81, s81, s82
  s_waitcnt vmcnt(4)
  buffer_load_dwordx4 a[88:91], v5, s[44:47], s81 offen
  s_add_u32 s81, s81, s82
  s_waitcnt vmcnt(4)
  buffer_load_dwordx4 a[92:95], v5, s[44:47], s81 offen
  s_add_u32 s81, s81, s82
  s_waitcnt vmcnt(4)
  buffer_load_dwordx4 a[96:99], v5, s[44:47], s81 offen
  s_add_u32 s81, s81, s82
  s_waitcnt vmcnt(4)
  buffer_load_dwordx4 a[100:103], v5, s[44:47], s81 offen
  s_add_u32 s81, s81, s82
  s_waitcnt vmcnt(4)
  buffer_load_dwordx4 a[104:107], v5, s[44:47], s81 offen
  s_add_u32 s81, s81, s82
  s_waitcnt vmcnt(4)
  buffer_load_dwordx4 a[108:111], v5, s[44:47], s81 offen
  s_add_u32 s81, s81, s82
  s_waitcnt vmcnt(4)
  buffer_load_dwordx4 a[112:115], v5, s[44:47], s81 offen
  s_add_u32 s81, s81, s82
  s_waitcnt vmcnt(4)
  buffer_load_dwordx4 a[116:119], v5, s[44:47], s81 offen
  s_add_u32 s81, s81, s82
  s_waitcnt vmcnt(4)
  buffer_load_dwordx4 a[120:123], v5, s[44:47], s81 offen
  s_add_u32 s81, s81, s82
  s_waitcnt vmcnt(4)
  buffer_load_dwordx4 a[124:127], v5, s[44:47], s81 offen
  s_add_u32 s81, s81, s82
  s_setpc_b64 s[60:61]
L_pv0:
  v_and_b32_dpp v16, v52, v12 row_newbcast:0 row_mask:0xf bank_mask:0xf
  v_and_b32_dpp v17, v52, v13 row_newbcast:0 row_mask:0xf bank_mask:0xf
  v_and_b32_dpp v18, v52, v14 row_newbcast:0 row_mask:0xf bank_mask:0xf
  v_and_b32_dpp v19, v52, v15 row_newbcast:0 row_mask:0xf bank_mask:0xf
  v_and_b32_dpp v20, v52, v12 row_newbcast:1 row_mask:0xf bank_mask:0xf
  v_and_b32_dpp v21, v52, v13 row_newbcast:1 row_mask:0xf bank_mask:0xf
  v_and_b32_dpp v22, v52, v14 row_newbcast:1 row_mask:0xf bank_mask:0xf
  v_and_b32_dpp v23, v52, v15 row_newbcast:1 row_mask:0xf bank_mask:0xf
  v_mfma_f32_16x16x32_bf16 v[24:27], v[16:19], a[0:3], v[24:27]
  v_and_b32_dpp v16, v52, v12 row_newbcast:2 row_mask:0xf bank_mask:0xf
  v_and_b32_dpp v17, v52, v13 row_newbcast:2 row_mask:0xf bank_mask:0xf
  v_and_b32_dpp v18, v52, v14 row_newbcast:2 row_mask:0xf bank_mask:0xf
  v_and_b32_dpp v19, v52, v15 row_newbcast:2 row_mask:0xf bank_mask:0xf
  v_mfma_f32_16x16x32_bf16 v[24:27], v[20:23], a[4:7], v[24:27]
  v_and_b32_dpp v20, v52, v12 row_newbcast:3 row_mask:0xf bank_mask:0xf
  v_and_b32_dpp v21, v52, v13 row_newbcast:3 row_mask:0xf bank_mask:0xf
  v_and_b32_dpp v22, v52, v14 row_newbcast:3 row_mask:0xf bank_mask:0xf
  v_and_b32_dpp v23, v52, v15 row_newbcast:3 row_mask:0xf bank_mask:0xf
  v_mfma_f32_16x16x32_bf16 v[24:27], v[16:19], a[8:11], v[24:27]
  v_and_b32_dpp v16, v52, v12 row_newbcast:4 row_mask:0xf bank_mask:0xf
  v_and_b32_dpp v17, v52, v13 row_newbcast:4 row_mask:0xf bank_mask:0xf
  v_and_b32_dpp v18, v52, v14 row_newbcast:4 row_mask:0xf bank_mask:0xf
  v_and_b32_dpp v19, v52, v15 row_newbcast:4 row_mask:0xf bank_mask:0xf
  v_mfma_f32_16x16x32_bf16 v[24:27], v[20:23], a[12:15], v[24:27]
  v_and_b32_dpp v20, v52, v12 row_newbcast:5 row_mask:0xf bank_mask:0xf
  v_and_b32_dpp v21, v52, v13 row_newbcast:5 row_mask:0xf bank_mask:0xf
  v_and_b32_dpp v22, v52, v14 row_newbcast:5 row_mask:0xf bank_mask:0xf
  v_and_b32_dpp v23, v52, v15 row_newbcast:5 row_mask:0xf bank_mask:0xf
  v_mfma_f32_16x16x32_bf16 v[24:27], v[16:19], a[16:19], v[24:27]
  v_and_b32_dpp v16, v52, v12 row_newbcast:6 row_mask:0xf bank_mask:0xf
  v_and_b32_dpp v17, v52, v13 row_newbcast:6 row_mask:0xf bank_mask:0xf
  v_and_b32_dpp v18, v52, v14 row_newbcast:6 row_mask:0xf bank_mask:0xf
  v_and_b32_dpp v19, v52, v15 row_newbcast:6 row_mask:0xf bank_mask:0xf
  v_mfma_f32_16x16x32_bf16 v[24:27], v[20:23], a[20:23], v[24:27]
  v_and_b32_dpp v20, v52, v12 row_newbcast:7 row_mask:0xf bank_mask:0xf
  v_and_b32_dpp v21, v52, v13 row_newbcast:7 row_mask:0xf bank_mask:0xf
  v_and_b32_dpp v22, v52, v14 row_newbcast:7 row_mask:0xf bank_mask:0xf
  v_and_b32_dpp v23, v52, v15 row_newbcast:7 row_mask:0xf bank_mask:0xf
  v_mfma_f32_16x16x32_bf16 v[24:27], v[16:19], a[24:27], v[24:27]
  v_and_b32_dpp v16, v52, v12 row_newbcast:8 row_mask:0xf bank_mask:0xf
  v_and_b32_dpp v17, v52, v13 row_newbcast:8 row_mask:0xf bank_mask:0xf
  v_and_b32_dpp v18, v52, v14 row_newbcast:8 row_mask:0xf bank_mask:0xf
  v_and_b32_dpp v19, v52, v15 row_newbcast:8 row_mask:0xf bank_mask:0xf
  v_mfma_f32_16x16x32_bf16 v[24:27], v[20:23], a[28:31], v[24:27]
  v_and_b32_dpp v20, v52, v12 row_newbcast:9 row_mask:0xf bank_mask:0xf
  v_and_b32_dpp v21, v52, v13 row_newbcast:9 row_mask:0xf bank_mask:0xf
  v_and_b32_dpp v22, v52, v14 row_newbcast:9 row_mask:0xf bank_mask:0xf
  v_and_b32_dpp v23, v52, v15 row_newbcast:9 row_mask:0xf bank_mask:0xf
  v_mfma_f32_16x16x32_bf16 v[24:27], v[16:19], a[32:35], v[24:27]
  v_and_b32_dpp v16, v52, v12 row_newbcast:10 row_mask:0xf bank_mask:0xf
  v_and_b32_dpp v17, v52, v13 row_newbcast:10 row_mask:0xf bank_mask:0xf
  v_and_b32_dpp v18, v52, v14 row_newbcast:10 row_mask:0xf bank_mask:0xf
  v_and_b32_dpp v19, v52, v15 row_newbcast:10 row_mask:0xf bank_mask:0xf
  v_mfma_f32_16x16x32_bf16 v[24:27], v[20:23], a[36:39], v[24:27]
  v_and_b32_dpp v20, v52, v12 row_newbcast:11 row_mask:0xf bank_mask:0xf
  v_and_b32_dpp v21, v52, v13 row_newbcast:11 row_mask:0xf bank_mask:0xf
  v_and_b32_dpp v22, v52, v14 row_newbcast:11 row_mask:0xf bank_mask:0xf
  v_and_b32_dpp v23, v52, v15 row_newbcast:11 row_mask:0xf bank_mask:0xf
  v_mfma_f32_16x16x32_bf16 v[24:27], v[16:19], a[40:43], v[24:27]
  v_and_b32_dpp v16, v52, v12 row_newbcast:12 row_mask:0xf bank_mask:0xf
  v_and_b32_dpp v17, v52, v13 row_newbcast:12 row_mask:0xf bank_mask:0xf
  v_and_b32_dpp v18, v52, v14 row_newbcast:12 row_mask:0xf bank_mask:0xf
  v_and_b32_dpp v19, v52, v15 row_newbcast:12 row_mask:0xf bank_mask:0xf
  v_mfma_f32_16x16x32_bf16 v[24:27], v[20:23], a[44:47], v[24:27]
  v_and_b32_dpp v20, v52, v12 row_newbcast:13 row_mask:0xf bank_mask:0xf
  v_and_b32_dpp v21, v52, v13 row_newbcast:13 row_mask:0xf bank_mask:0xf
  v_and_b32_dpp v22, v52, v14 row_newbcast:13 row_mask:0xf bank_mask:0xf
  v_and_b32_dpp v23, v52, v15 row_newbcast:13 row_mask:0xf bank_mask:0xf
  v_mfma_f32_16x16x32_bf16 v[24:27], v[16:19], a[48:51], v[24:27]
  v_and_b32_dpp v16, v52, v12 row_newbcast:14 row_mask:0xf bank_mask:0xf
  v_and_b32_dpp v17, v52, v13 row_newbcast:14 row_mask:0xf bank_mask:0xf
  v_and_b32_dpp v18, v52, v14 row_newbcast:14 row_mask:0xf bank_mask:0xf
  v_and_b32_dpp v19, v52, v15 row_newbcast:14 row_mask:0xf bank_mask:0xf
  v_mfma_f32_16x16x32_bf16 v[24:27], v[20:23], a[52:55], v[24:27]
  v_and_b32_dpp v20, v52, v12 row_newbcast:15 row_mask:0xf bank_mask:0xf
  v_and_b32_dpp v21, v52, v13 row_newbcast:15 row_mask:0xf bank_mask:0xf
  v_and_b32_dpp v22, v52, v14 row_newbcast:15 row_mask:0xf bank_mask:0xf
  v_and_b32_dpp v23, v52, v15 row_newbcast:15 row_mask:0xf bank_mask:0xf
  v_mfma_f32_16x16x32_bf16 v[24:27], v[16:19], a[56:59], v[24:27]
  v_mov_b32 v52, v53
  v_mov_b32 v53, v54
  v_mov_b32 v54, v55
  v_mfma_f32_16x16x32_bf16 v[24:27], v[20:23], a[60:63], v[24:27]
  s_setpc_b64 s[60:61]
L_pv1:
  v_and_b32_dpp v16, v52, v12 row_newbcast:0 row_mask:0xf bank_mask:0xf
  v_and_b32_dpp v17, v52, v13 row_newbcast:0 row_mask:0xf bank_mask:0xf
  v_and_b32_dpp v18, v52, v14 row_newbcast:0 row_mask:0xf bank_mask:0xf
  v_and_b32_dpp v19, v52, v15 row_newbcast:0 row_mask:0xf bank_mask:0xf
  v_and_b32_dpp v20, v52, v12 row_newbcast:1 row_mask:0xf bank_mask:0xf
  v_and_b32_dpp v21, v52, v13 row_newbcast:1 row_mask:0xf bank_mask:0xf
  v_and_b32_dpp v22, v52, v14 row_newbcast:1 row_mask:0xf bank_mask:0xf
  v_and_b32_dpp v23, v52, v15 row_newbcast:1 row_mask:0xf bank_mask:0xf
  v_mfma_f32_16x16x32_bf16 v[24:27], v[16:19], a[64:67], v[24:27]
  v_and_b32_dpp v16, v52, v12 row_newbcast:2 row_mask:0xf bank_mask:0xf
  v_and_b32_dpp v17, v52, v13 row_newbcast:2 row_mask:0xf bank_mask:0xf
  v_and_b32_dpp v18, v52, v14 row_newbcast:2 row_mask:0xf bank_mask:0xf
  v_and_b32_dpp v19, v52, v15 row_newbcast:2 row_mask:0xf bank_mask:0xf
  v_mfma_f32_16x16x32_bf16 v[24:27], v[20:23], a[68:71], v[24:27]
  v_and_b32_dpp v20, v52, v12 row_newbcast:3 row_mask:0xf bank_mask:0xf
  v_and_b32_dpp v21, v52, v13 row_newbcast:3 row_mask:0xf bank_mask:0xf
  v_and_b32_dpp v22, v52, v14 row_newbcast:3 row_mask:0xf bank_mask:0xf
  v_and_b32_dpp v23, v52, v15 row_newbcast:3 row_mask:0xf bank_mask:0xf
  v_mfma_f32_16x16x32_bf16 v[24:27], v[16:19], a[72:75], v[24:27]
  v_and_b32_dpp v16, v52, v12 row_newbcast:4 row_mask:0xf bank_mask:0xf
  v_and_b32_dpp v17, v52, v13 row_newbcast:4 row_mask:0xf bank_mask:0xf
  v_and_b32_dpp v18, v52, v14 row_newbcast:4 row_mask:0xf bank_mask:0xf
  v_and_b32_dpp v19, v52, v15 row_newbcast:4 row_mask:0xf bank_mask:0xf
  v_mfma_f32_16x16x32_bf16 v[24:27], v[20:23], a[76:79], v[24:27]
  v_and_b32_dpp v20, v52, v12 row_newbcast:5 row_mask:0xf bank_mask:0xf
  v_and_b32_dpp v21, v52, v13 row_newbcast:5 row_mask:0xf bank_mask:0xf
  v_and_b32_dpp v22, v52, v14 row_newbcast:5 row_mask:0xf bank_mask:0xf
  v_and_b32_dpp v23, v52, v15 row_newbcast:5 row_mask:0xf bank_mask:0xf
  v_mfma_f32_16x16x32_bf16 v[24:27], v[16:19], a[80:83], v[24:27]
  v_and_b32_dpp v16, v52, v12 row_newbcast:6 row_mask:0xf bank_mask:0xf
  v_and_b32_dpp v17, v52, v13 row_newbcast:6 row_mask:0xf bank_mask:0xf
  v_and_b32_dpp v18, v52, v14 row_newbcast:6 row_mask:0xf bank_mask:0xf
  v_and_b32_dpp v19, v52, v15 row_newbcast:6 row_mask:0xf bank_mask:0xf
  v_mfma_f32_16x16x32_bf16 v[24:27], v[20:23], a[84:87], v[24:27]
  v_and_b32_dpp v20, v52, v12 row_newbcast:7 row_mask:0xf bank_mask:0xf
  v_and_b32_dpp v21, v52, v13 row_newbcast:7 row_mask:0xf bank_mask:0xf
  v_and_b32_dpp v22, v52, v14 row_newbcast:7 row_mask:0xf bank_mask:0xf
  v_and_b32_dpp v23, v52, v15 row_newbcast:7 row_mask:0xf bank_mask:0xf
  v_mfma_f32_16x16x32_bf16 v[24:27], v[16:19], a[88:91], v[24:27]
  v_and_b32_dpp v16, v52, v12 row_newbcast:8 row_mask:0xf bank_mask:0xf
  v_and_b32_dpp v17, v52, v13 row_newbcast:8 row_mask:0xf bank_mask:0xf
  v_and_b32_dpp v18, v52, v14 row_newbcast:8 row_mask:0xf bank_mask:0xf
  v_and_b32_dpp v19, v52, v15 row_newbcast:8 row_mask:0xf bank_mask:0xf
  v_mfma_f32_16x16x32_bf16 v[24:27], v[20:23], a[92:95], v[24:27]
  v_and_b32_dpp v20, v52, v12 row_newbcast:9 row_mask:0xf bank_mask:0xf
  v_and_b32_dpp v21, v52, v13 row_newbcast:9 row_mask:0xf bank_mask:0xf
  v_and_b32_dpp v22, v52, v14 row_newbcast:9 row_mask:0xf bank_mask:0xf
  v_and_b32_dpp v23, v52, v15 row_newbcast:9 row_mask:0xf bank_mask:0xf
  v_mfma_f32_16x16x32_bf16 v[24:27], v[16:19], a[96:99], v[24:27]
  v_and_b32_dpp v16, v52, v12 row_newbcast:10 row_mask:0xf bank_mask:0xf
  v_and_b32_dpp v17, v52, v13 row_newbcast:10 row_mask:0xf bank_mask:0xf
  v_and_b32_dpp v18, v52, v14 row_newbcast:10 row_mask:0xf bank_mask:0xf
  v_and_b32_dpp v19, v52, v15 row_newbcast:10 row_mask:0xf bank_mask:0xf
  v_mfma_f32_16x16x32_bf16 v[24:27], v[20:23], a[100:103], v[24:27]
  v_and_b32_dpp v20, v52, v12 row_newbcast:11 row_mask:0xf bank_mask:0xf
  v_and_b32_dpp v21, v52, v13 row_newbcast:11 row_mask:0xf bank_mask:0xf
  v_and_b32_dpp v22, v52, v14 row_newbcast:11 row_mask:0xf bank_mask:0xf
  v_and_b32_dpp v23, v52, v15 row_newbcast:11 row_mask:0xf bank_mask:0xf
  v_mfma_f32_16x16x32_bf16 v[24:27], v[16:19], a[104:107], v[24:27]
  v_and_b32_dpp v16, v52, v12 row_newbcast:12 row_mask:0xf bank_mask:0xf
  v_and_b32_dpp v17, v52, v13 row_newbcast:12 row_mask:0xf bank_mask:0xf
  v_and_b32_dpp v18, v52, v14 row_newbcast:12 row_mask:0xf bank_mask:0xf
  v_and_b32_dpp v19, v52, v15 row_newbcast:12 row_mask:0xf bank_mask:0xf
  v_mfma_f32_16x16x32_bf16 v[24:27], v[20:23], a[108:111], v[24:27]
  v_and_b32_dpp v20, v52, v12 row_newbcast:13 row_mask:0xf bank_mask:0xf
  v_and_b32_dpp v21, v52, v13 row_newbcast:13 row_mask:0xf bank_mask:0xf
  v_and_b32_dpp v22, v52, v14 row_newbcast:13 row_mask:0xf bank_mask:0xf
  v_and_b32_dpp v23, v52, v15 row_newbcast:13 row_mask:0xf bank_mask:0xf
  v_mfma_f32_16x16x32_bf16 v[24:27], v[16:19], a[112:115], v[24:27]
  v_and_b32_dpp v16, v52, v12 row_newbcast:14 row_mask:0xf bank_mask:0xf
  v_and_b32_dpp v17, v52, v13 row_newbcast:14 row_mask:0xf bank_mask:0xf
  v_and_b32_dpp v18, v52, v14 row_newbcast:14 row_mask:0xf bank_mask:0xf
  v_and_b32_dpp v19, v52, v15 row_newbcast:14 row_mask:0xf bank_mask:0xf
  v_mfma_f32_16x16x32_bf16 v[24:27], v[20:23], a[116:119], v[24:27]
  v_and_b32_dpp v20, v52, v12 row_newbcast:15 row_mask:0xf bank_mask:0xf
  v_and_b32_dpp v21, v52, v13 row_newbcast:15 row_mask:0xf bank_mask:0xf
  v_and_b32_dpp v22, v52, v14 row_newbcast:15 row_mask:0xf bank_mask:0xf
  v_and_b32_dpp v23, v52, v15 row_newbcast:15 row_mask:0xf bank_mask:0xf
  v_mfma_f32_16x16x32_bf16 v[24:27], v[16:19], a[120:123], v[24:27]
  v_mov_b32 v52, v53
  v_mov_b32 v53, v54
  v_mov_b32 v54, v55
  v_mfma_f32_16x16x32_bf16 v[24:27], v[20:23], a[124:127], v[24:27]
  s_setpc_b64 s[60:61]
L_subbar:
  s_add_u32 s87, s87, 4
  v_mov_b32 v76, 1
  s_waitcnt lgkmcnt(0)
  s_mov_b64 exec, 1
  ds_add_u32 v6, v76 offset:8592
  s_mov_b64 exec, -1
  s_mov_b32 s88, 0x1000000
L_sb_loop:
  ds_read_b32 v76, v6 offset:8592
  s_waitcnt lgkmcnt(0)
  v_readfirstlane_b32 s90, v76
  s_sub_u32 s88, s88, 1
  s_cbranch_scc1 L_sb_out
  s_cmp_ge_u32 s90, s87
  s_cbranch_scc1 L_sb_out
  s_sleep 1
  s_branch L_sb_loop
L_sb_out:
  s_setpc_b64 s[60:61]
L_qk0:
  v_mov_b32 v52, v53
  v_mov_b32 v53, v54
  v_mov_b32 v54, v55
  v_mfma_f32_16x16x32_bf16 v[28:31], a[0:3], v[36:39], 0
  v_mfma_f32_16x16x32_bf16 v[28:31], a[4:7], v[40:43], v[28:31]
  v_mfma_f32_16x16x32_bf16 v[28:31], a[8:11], v[44:47], v[28:31]
  v_mfma_f32_16x16x32_bf16 v[28:31], a[12:15], v[48:51], v[28:31]
  v_mfma_f32_16x16x32_bf16 v[32:35], a[16:19], v[36:39], 0
  v_mfma_f32_16x16x32_bf16 v[32:35], a[20:23], v[40:43], v[32:35]
  v_mfma_f32_16x16x32_bf16 v[32:35], a[24:27], v[44:47], v[32:35]
  v_mfma_f32_16x16x32_bf16 v[32:35], a[28:31], v[48:51], v[32:35]
  s_nop 3
  v_add_f32_dpp v55, v29, v28 row_ror:12 row_mask:0xf bank_mask:0x1
  s_nop 1
  v_add_f32_dpp v55, v30, v55 row_ror:8 row_mask:0xf bank_mask:0x1
  s_nop 1
  v_add_f32_dpp v55, v31, v55 row_ror:4 row_mask:0xf bank_mask:0x1
  s_nop 1
  v_mfma_f32_16x16x32_bf16 v[28:31], a[32:35], v[36:39], 0
  v_mfma_f32_16x16x32_bf16 v[28:31], a[36:39], v[40:43], v[28:31]
  v_mfma_f32_16x16x32_bf16 v[28:31], a[40:43], v[44:47], v[28:31]
  v_mfma_f32_16x16x32_bf16 v[28:31], a[44:47], v[48:51], v[28:31]
  s_nop 3
  v_add_f32_dpp v55, v32, v33 row_ror:4 row_mask:0xf bank_mask:0x2
  s_nop 1
  v_add_f32_dpp v55, v34, v55 row_ror:12 row_mask:0xf bank_mask:0x2
  s_nop 1
  v_add_f32_dpp v55, v35, v55 row_ror:8 row_mask:0xf bank_mask:0x2
  s_nop 1
  v_mfma_f32_16x16x32_bf16 v[32:35], a[48:51], v[36:39], 0
  v_mfma_f32_16x16x32_bf16 v[32:35], a[52:55], v[40:43], v[32:35]
  v_mfma_f32_16x16x32_bf16 v[32:35], a[56:59], v[44:47], v[32:35]
  v_mfma_f32_16x16x32_bf16 v[32:35], a[60:63], v[48:51], v[32:35]
  s_nop 3
  v_add_f32_dpp v55, v28, v30 row_ror:8 row_mask:0xf bank_mask:0x4
  s_nop 1
  v_add_f32_dpp v55, v29, v55 row_ror:4 row_mask:0xf bank_mask:0x4
  s_nop 1
  v_add_f32_dpp v55, v31, v55 row_ror:12 row_mask:0xf bank_mask:0x4
  s_nop 1
  s_nop 1
  v_add_f32_dpp v55, v32, v35 row_ror:12 row_mask:0xf bank_mask:0x8
  s_nop 1
  v_add_f32_dpp v55, v33, v55 row_ror:8 row_mask:0xf bank_mask:0x8
  s_nop 1
  v_add_f32_dpp v55, v34, v55 row_ror:4 row_mask:0xf bank_mask:0x8
  s_nop 1
  s_setpc_b64 s[60:61]
L_qk1:
  v_mov_b32 v52, v53
  v_mov_b32 v53, v54
  v_mov_b32 v54, v55
  v_mfma_f32_16x16x32_bf16 v[28:31], a[64:67], v[36:39], 0
  v_mfma_f32_16x16x32_bf16 v[28:31], a[68:71], v[40:43], v[28:31]
  v_mfma_f32_16x16x32_bf16 v[28:31], a[72:75], v[44:47], v[28:31]
  v_mfma_f32_16x16x32_bf16 v[28:31], a[76:79], v[48:51], v[28:31]
  v_mfma_f32_16x16x32_bf16 v[32:35], a[80:83], v[36:39], 0
  v_mfma_f32_16x16x32_bf16 v[32:35], a[84:87], v[40:43], v[32:35]
  v_mfma_f32_16x16x32_bf16 v[32:35], a[88:91], v[44:47], v[32:35]
  v_mfma_f32_16x16x32_bf16 v[32:35], a[92:95], v[48:51], v[32:35]
  s_nop 3
  v_add_f32_dpp v55, v29, v28 row_ror:12 row_mask:0xf bank_mask:0x1
  s_nop 1
  v_add_f32_dpp v55, v30, v55 row_ror:8 row_mask:0xf bank_mask:0x1
  s_nop 1
  v_add_f32_dpp v55, v31, v55 row_ror:4 row_mask:0xf bank_mask:0x1
  s_nop 1
  v_mfma_f32_16x16x32_bf16 v[28:31], a[96:99], v[36:39], 0
  v_mfma_f32_16x16x32_bf16 v[28:31], a[100:103], v[40:43], v[28:31]
  v_mfma_f32_16x16x32_bf16 v[28:31], a[104:107], v[44:47], v[28:31]
  v_mfma_f32_16x16x32_bf16 v[28:31], a[108:111], v[48:51], v[28:31]
  s_nop 3
  v_add_f32_dpp v55, v32, v33 row_ror:4 row_mask:0xf bank_mask:0x2
  s_nop 1
  v_add_f32_dpp v55, v34, v55 row_ror:12 row_mask:0xf bank_mask:0x2
  s_nop 1
  v_add_f32_dpp v55, v35, v55 row_ror:8 row_mask:0xf bank_mask:0x2
  s_nop 1
  v_mfma_f32_16x16x32_bf16 v[32:35], a[112:115], v[36:39], 0
  v_mfma_f32_16x16x32_bf16 v[32:35], a[116:119], v[40:43], v[32:35]
  v_mfma_f32_16x16x32_bf16 v[32:35], a[120:123], v[44:47], v[32:35]
  v_mfma_f32_16x16x32_bf16 v[32:35], a[124:127], v[48:51], v[32:35]
  s_nop 3
  v_add_f32_dpp v55, v28, v30 row_ror:8 row_mask:0xf bank_mask:0x4
  s_nop 1
  v_add_f32_dpp v55, v29, v55 row_ror:4 row_mask:0xf bank_mask:0x4
  s_nop 1
  v_add_f32_dpp v55, v31, v55 row_ror:12 row_mask:0xf bank_mask:0x4
  s_nop 1
  s_nop 1
  v_add_f32_dpp v55, v32, v35 row_ror:12 row_mask:0xf bank_mask:0x8
  s_nop 1
  v_add_f32_dpp v55, v33, v55 row_ror:8 row_mask:0xf bank_mask:0x8
  s_nop 1
  v_add_f32_dpp v55, v34, v55 row_ror:4 row_mask:0xf bank_mask:0x8
  s_nop 1
  s_setpc_b64 s[60:61]
L_gather:
  s_mov_b32 s88, 0x100000
  s_mov_b64 exec, s[56:57]
L_g_loop:
  buffer_load_dwordx4 v[76:79], v70, s[52:55], s4 offen sc1
  buffer_load_dwordx4 v[80:83], v70, s[52:55], s4 offen offset:2048 sc1
  s_waitcnt vmcnt(1)
  v_xor_b32 v76, v76, v72
  v_xor_b32 v77, v77, v73
  v_xor_b32 v78, v78, v74
  v_xor_b32 v79, v79, v75
  v_or3_b32 v32, v77, v78, v79
  v_bfe_u32 v33, v76, 4, 8
  v_and_or_b32 v32, v76, 15, v32
  v_lshlrev_b32 v33, v62, v33
  v_and_b32 v76, s6, v76
  s_nop 0
  v_or_b32_dpp v33, v33, v33 quad_perm:[1,0,3,2] row_mask:0xf bank_mask:0xf
  s_nop 1
  v_or_b32_dpp v33, v33, v33 quad_perm:[2,3,0,1] row_mask:0xf bank_mask:0xf
  s_waitcnt vmcnt(0)
  v_bfe_u32 v34, v80, 4, 8
  v_xor_b32 v80, v80, v72
  v_lshlrev_b32 v34, v62, v34
  v_xor_b32 v81, v81, v73
  v_and_or_b32 v32, v80, 15, v32
  v_or_b32_dpp v34, v34, v34 quad_perm:[1,0,3,2] row_mask:0xf bank_mask:0xf
  v_xor_b32 v82, v82, v74
  v_xor_b32 v83, v83, v75
  v_or_b32_dpp v34, v34, v34 quad_perm:[2,3,0,1] row_mask:0xf bank_mask:0xf
  v_or3_b32 v32, v81, v82, v32
  v_sub_f32 v34, v34, v33
  v_or_b32 v32, v83, v32
  v_exp_f32 v34, v34
  v_and_b32 v80, s6, v80
  v_or_b32_dpp v32, v32, v32 quad_perm:[1,0,3,2] row_mask:0xf bank_mask:0xf
  v_add_f32 v34, 1.0, v34
  v_rcp_f32 v33, v34
  v_or_b32_dpp v32, v32, v32 quad_perm:[2,3,0,1] row_mask:0xf bank_mask:0xf
  v_sub_f32 v34, 1.0, v33
  v_lshlrev_b32 v32, 20, v32
  v_cmp_ne_u32 vcc, 0, v32
  s_andn2_b64 exec, exec, vcc
  v_fmac_f32 v65, v33, v76
  v_fmac_f32 v66, v33, v77
  v_fmac_f32 v67, v33, v78
  v_fmac_f32 v68, v33, v79
  v_fmac_f32 v65, v34, v80
  v_fmac_f32 v66, v34, v81
  v_fmac_f32 v67, v34, v82
  v_fmac_f32 v68, v34, v83
  s_mov_b64 exec, vcc
  s_cbranch_vccz L_g_out
  s_sub_u32 s88, s88, 1
  s_cbranch_scc1 L_g_out
  s_cmp_eq_u32 s86, 0
  s_cbranch_scc1 L_g_loop
  s_sleep 32
  s_cmp_eq_u32 s86, 2
  s_cbranch_scc1 L_g_loop
  ds_read_b32 v32, v6 offset:8600
  s_waitcnt lgkmcnt(0)
  v_readfirstlane_b32 s90, v32
  s_cmp_eq_u32 s90, 0
  s_cbranch_scc1 L_g_loop
  s_mov_b64 s[56:57], exec
  s_mov_b64 exec, -1
  s_mov_b32 s86, 2
  s_setpc_b64 s[60:61]
L_g_out:
  s_mov_b64 exec, -1
  s_setpc_b64 s[60:61]
L_qg:
  s_mov_b32 s88, 131072
  s_branch L_qx
L_qx_sl:
  s_sleep 16
L_qx:
  buffer_load_dwordx4 v[44:47], v69, s[52:55], s13 offen offset:0 sc1
  buffer_load_dwordx4 v[48:51], v69, s[52:55], s13 offen offset:1024 sc1
  s_waitcnt vmcnt(1)
  v_xor_b32 v44, v44, v124
  v_xor_b32 v45, v45, v125
  v_xor_b32 v46, v46, v126
  v_xor_b32 v47, v47, v127
  v_or3_b32 v28, v44, v45, 0
  v_or3_b32 v28, v46, v47, v28
  s_waitcnt vmcnt(0)
  v_xor_b32 v48, v48, v124
  v_xor_b32 v49, v49, v125
  v_xor_b32 v50, v50, v126
  v_xor_b32 v51, v51, v127
  v_or3_b32 v28, v48, v49, v28
  v_or3_b32 v28, v50, v51, v28
  v_and_b32 v28, 0x3ff, v28
  v_cmp_ne_u32 vcc, 0, v28
  s_sub_u32 s88, s88, 1
  s_cbranch_scc1 L_qx_out
  s_and_b64 exec, exec, vcc
  s_cbranch_execnz L_qx_sl
L_qx_out:
  s_mov_b64 exec, -1
  v_add_f32 v44, v44, v48
  v_add_f32 v46, v46, v50
  v_add_f32 v45, v45, v49
  v_add_f32 v47, v47, v51
  v_permlane32_swap_b32 v44, v46
  s_nop 0
  v_permlane32_swap_b32 v45, v47
  v_add_f32 v44, v44, v46
  s_nop 0
  v_add_f32 v45, v45, v47
  v_cvt_pk_bf16_f32 v44, v44, v45
  ds_write_b32 v84, v44
  s_mov_b64 exec, 1
  buffer_store_dwordx4 v[124:127], v6, s[52:55], s14 offen sc1
  s_mov_b64 exec, -1
  s_setpc_b64 s[60:61]
.section .rodata,"a"
.p2align 6
.amdhsa_kernel gated_mix__mha_block_cached__sliding_block_cached__decode_kernel
  .amdhsa_next_free_vgpr 256
  .amdhsa_next_free_sgpr 102
  .amdhsa_accum_offset 128
  .amdhsa_group_segment_fixed_size 0
  .amdhsa_kernarg_size 112
  .amdhsa_user_sgpr_count 2
  .amdhsa_user_sgpr_kernarg_segment_ptr 1
  .amdhsa_system_sgpr_workgroup_id_x 1
.end_amdhsa_kernel
```
